```python
import torch

def _softmax(x, axis=-1):
    return torch.softmax(x, dim=axis)
def _gelu(x):
    return torch.nn.functional.gelu(x, approximate="tanh")
def _silu(x):
    return torch.nn.functional.silu(x)
def _sigmoid(x):
    return torch.sigmoid(x)
def _layernorm(x, axis=-1, eps=1e-5):
    m = x.mean(dim=axis, keepdim=True)
    v = x.var(dim=axis, keepdim=True, unbiased=False)
    return (x - m) / torch.sqrt(v + eps)
def _scatter_add(tgt, idx, src, axis=0):
    return tgt.clone().index_add_(axis, idx, src)
def _segment_sum(src, seg, n):
    out = torch.zeros((n,) + src.shape[1:], dtype=src.dtype)
    return out.index_add_(0, seg, src)
def _pad(x, pw):
    flat = tuple(v for pair in reversed(pw) for v in pair)
    return torch.nn.functional.pad(x, flat)

kernel_name = 'recurrent_scan__ssm_conv_s4__mixer_s_mlp__prompt'

def setup_inputs():

    _w = (lambda a: (lambda t: t.to(torch.bfloat16) if t.is_floating_point() else t)(torch.as_tensor(a)))
    def _A_setup():
        B, L, D, N = 1, 2048, 448, 256
        A_re = -(lambda _x: torch.exp(torch.as_tensor(_x)))((lambda *s: torch.randn(*s, dtype=torch.bfloat16) * 3.2)(D, N))
        A_im = torch.pi * (lambda *s: torch.randn(*s, dtype=torch.bfloat16) * 0.05)(D, N)
        B_re = (lambda *s: torch.randn(*s, dtype=torch.bfloat16) * 0.1)(D, N)
        B_im = (lambda *s: torch.randn(*s, dtype=torch.bfloat16) * 0.1)(D, N)
        C_re = (lambda *s: torch.randn(*s, dtype=torch.bfloat16) * 0.1)(D, N)
        C_im = (lambda *s: torch.randn(*s, dtype=torch.bfloat16) * 0.1)(D, N)
        log_dt = (lambda *s: torch.randn(*s, dtype=torch.bfloat16) * 0.05)(D) * 0.5 - 4.0
        Dskip = (lambda *s: torch.randn(*s, dtype=torch.bfloat16) * 0.05)(D)
        return {
            "u": _w((lambda *s: torch.randn(*s, dtype=torch.bfloat16) * 0.05)(B, L, D)),
            "A_re": _w(A_re),
            "A_im": _w(A_im),
            "B_re": _w(B_re),
            "B_im": _w(B_im),
            "C_re": _w(C_re),
            "C_im": _w(C_im),
            "log_dt": _w(log_dt),
            "Dskip": _w(Dskip),
        }
    _A_in = _A_setup()

    def _B_setup():
        B, S, D, F = 1, 2048, 448, 1792
        return {
            "x":  _w((lambda *s: torch.randn(*s, dtype=torch.bfloat16) * 0.05)(B, S, D)),
            "w1": _w((lambda *s: torch.randn(*s, dtype=torch.bfloat16) * 3.2)(D, D) * (D ** -0.5)),
            "w2": _w((lambda *s: torch.randn(*s, dtype=torch.bfloat16) * 3.2)(D, D) * (D ** -0.5)),
            "w3": _w((lambda *s: torch.randn(*s, dtype=torch.bfloat16) * 3.2)(D, F) * (D ** -0.5)),
            "w4": _w((lambda *s: torch.randn(*s, dtype=torch.bfloat16) * 3.2)(F, D) * (F ** -0.5)),
        }
    _B_in = _B_setup()

    return {
        "A_u": _A_in["u"],
        "A_A_re": _A_in["A_re"],
        "A_A_im": _A_in["A_im"],
        "A_B_re": _A_in["B_re"],
        "A_B_im": _A_in["B_im"],
        "A_C_re": _A_in["C_re"],
        "A_C_im": _A_in["C_im"],
        "A_log_dt": _A_in["log_dt"],
        "A_Dskip": _A_in["Dskip"],
        "B_x": _B_in["x"],
        "B_w1": _B_in["w1"],
        "B_w2": _B_in["w2"],
        "B_w3": _B_in["w3"],
        "B_w4": _B_in["w4"],
    }

def reference(A_u, A_A_re, A_A_im, A_B_re, A_B_im, A_C_re, A_C_im, A_log_dt, A_Dskip, B_x, B_w1, B_w2, B_w3, B_w4):
    def _A_ref(u, A_re, A_im, B_re, B_im, C_re, C_im, log_dt, Dskip):
        Bsz, L, D = u.shape
        dt = torch.exp(log_dt)[:, None]
        A = A_re + 1j * A_im
        Bc = B_re + 1j * B_im
        Cc = C_re + 1j * C_im
        logdA = dt * A
        dB = dt * Bc
        l = (lambda x, dt: x.to(dt))(torch.arange(L), A_re.dtype)
        P = torch.exp(logdA[:, :, None] * l[None, None, :])
        K = torch.einsum("dn,dnl,dn->dl", Cc, P, dB).real
        L2 = 2 * L
        Kp = _pad(K, ((0, 0), (0, L)))
        up = (lambda x, *d: x.permute(*d))(u, 0, 2, 1)
        up = _pad(up, ((0, 0), (0, 0), (0, L)))
        Kf = (lambda x, axes=(-2,-1): torch.fft.rfft2(x.float(), dim=axes))(Kp[:, None, :], axes=(-2, -1))
        Uf = (lambda x, axes=(-2,-1): torch.fft.rfft2(x.float(), dim=axes))(up[:, :, None, :], axes=(-2, -1))
        Yf = Uf * Kf[None, :, :, :]
        y = (lambda x, s, axes=(-2,-1): torch.fft.irfft2(x, s=s, dim=axes).to(torch.bfloat16))(Yf, (1, L2), axes=(-2, -1))[:, :, 0, :L]
        y = (lambda x, *d: x.permute(*d))(y, 0, 2, 1) + u * Dskip[None, None, :]
        return y

    def _B_ref(x, w1, w2, w3, w4):
        B, S, D = x.shape
        h = _gelu(_layernorm(x, axis=-1) @ w1)
        c = D // 4
        g0 = _pad(h[:, :, 0*c:1*c], ((0, 0), (1, 0), (0, 0)))[:, :S, :]
        g1 = _pad(h[:, :, 1*c:2*c], ((0, 0), (0, 1), (0, 0)))[:, 1:, :]
        g2 = _pad(h[:, :, 2*c:3*c], ((0, 0), (2, 0), (0, 0)))[:, :S, :]
        g3 = _pad(h[:, :, 3*c:   ], ((0, 0), (0, 2), (0, 0)))[:, 2:, :]
        hs = torch.concatenate([g0, g1, g2, g3], axis=-1) @ w2
        x1 = x + hs
        h2 = _gelu(_layernorm(x1, axis=-1) @ w3) @ w4
        return x1 + h2

    x = A_u
    xn = _layernorm(x, axis=-1)
    s = _A_ref(xn, A_A_re, A_A_im, A_B_re, A_B_im, A_C_re, A_C_im, A_log_dt, A_Dskip)
    g = _silu(_B_ref(xn, B_w1, B_w2, B_w3, B_w4))
    return x + s * g
```

```asm
; @launch grid=(256,1,1) block=(512,1,1) lds=163840
.amdgcn_target "amdgcn-amd-amdhsa--gfx950"
.text
.globl recurrent_scan__ssm_conv_s4__mixer_s_mlp__prompt_kernel
.p2align 8
.type recurrent_scan__ssm_conv_s4__mixer_s_mlp__prompt_kernel,@function
recurrent_scan__ssm_conv_s4__mixer_s_mlp__prompt_kernel:
  s_cmp_ge_u32 s2, 224
  s_cbranch_scc1 HELPER
  s_load_dwordx16 s[16:31], s[0:1], 0
  s_load_dwordx2 s[46:47], s[0:1], 128
  s_load_dwordx4 s[36:39], s[0:1], 80
  s_load_dwordx4 s[40:43], s[0:1], 96
  s_load_dwordx2 s[32:33], s[0:1], 64
  s_load_dwordx2 s[44:45], s[0:1], 112
  v_lshrrev_b32 v2, 6, v0
  v_and_b32 v0, 63, v0
  s_and_b32 s55, s2, 7
  v_readfirstlane_b32 s91, v2
  s_lshr_b32 s56, s2, 3
  s_mul_i32 s57, s56, 37
  s_lshr_b32 s57, s57, 8
  s_mul_i32 s58, s57, 7
  s_sub_u32 s51, s56, s58
  s_lshl_b32 s55, s55, 2
  s_add_u32 s50, s55, s57
  s_and_b32 s52, s91, 3
  s_lshr_b32 s53, s52, 1
  s_and_b32 s54, s52, 1
  s_mov_b32 s97, 0
  v_lshlrev_b32 v2, 4, v0
  v_and_b32 v14, 31, v0
  v_lshrrev_b32 v15, 5, v0
  s_cmp_ge_u32 s91, 4
  s_cbranch_scc1 SROLE
  s_setprio 2
  s_lshl_b32 s55, s50, 6
  s_lshl_b32 s56, s52, 4
  s_add_u32 s55, s55, s56
  s_mul_i32 s57, s55, 896
  s_add_u32 s58, s51, 0
  s_and_b32 s58, s58, 7
  s_lshl_b32 s55, s58, 4
  v_xor_b32 v56, s55, v2
  s_mulk_i32 s58, 1792
  s_add_u32 s55, s57, s58
  v_add_u32 v56, s55, v56
  s_add_u32 s59, s51, 1
  s_and_b32 s59, s59, 7
  s_lshl_b32 s55, s59, 4
  v_xor_b32 v57, s55, v2
  s_mulk_i32 s59, 1792
  s_add_u32 s55, s57, s59
  v_add_u32 v57, s55, v57
  s_add_u32 s60, s51, 2
  s_and_b32 s60, s60, 7
  s_lshl_b32 s55, s60, 4
  v_xor_b32 v58, s55, v2
  s_mulk_i32 s60, 1792
  s_add_u32 s55, s57, s60
  v_add_u32 v58, s55, v58
  s_add_u32 s61, s51, 3
  s_and_b32 s61, s61, 7
  s_lshl_b32 s55, s61, 4
  v_xor_b32 v59, s55, v2
  s_mulk_i32 s61, 1792
  s_add_u32 s55, s57, s61
  v_add_u32 v59, s55, v59
  s_add_u32 s62, s51, 4
  s_and_b32 s62, s62, 7
  s_lshl_b32 s55, s62, 4
  v_xor_b32 v60, s55, v2
  s_mulk_i32 s62, 1792
  s_add_u32 s55, s57, s62
  v_add_u32 v60, s55, v60
  s_add_u32 s63, s51, 5
  s_and_b32 s63, s63, 7
  s_lshl_b32 s55, s63, 4
  v_xor_b32 v61, s55, v2
  s_mulk_i32 s63, 1792
  s_add_u32 s55, s57, s63
  v_add_u32 v61, s55, v61
  s_add_u32 s64, s51, 6
  s_and_b32 s64, s64, 7
  s_lshl_b32 s55, s64, 4
  v_xor_b32 v62, s55, v2
  s_mulk_i32 s64, 1792
  s_add_u32 s55, s57, s64
  v_add_u32 v62, s55, v62
  s_add_u32 s65, s51, 7
  s_and_b32 s65, s65, 7
  s_lshl_b32 s55, s65, 4
  v_xor_b32 v63, s55, v2
  s_mulk_i32 s65, 1792
  s_add_u32 s55, s57, s65
  v_add_u32 v63, s55, v63
  s_mul_i32 s67, s52, 14336
  s_add_u32 s67, s67, 47104
  s_mov_b32 s10, 401408
  s_mov_b32 s11, 0x20000
  s_and_b32 s55, s50, 3
  s_mul_i32 s72, s55, 7
  s_add_u32 s72, s72, 1
  s_lshr_b32 s72, s72, 1
  s_lshl_b32 s72, s72, 10
  s_mul_i32 s93, s52, 100352
  s_lshl_b32 s56, s51, 7
  s_add_u32 s93, s93, s56
  s_mul_i32 s94, s52, 14336
  s_add_u32 s94, s94, 104448
  v_lshrrev_b32 v55, 3, v0
  v_mul_u32_u24 v52, 896, v55
  v_lshlrev_b32 v55, 1, v55
  v_and_b32 v55, 4, v55
  v_and_b32 v53, 7, v0
  v_xor_b32 v55, v55, v53
  v_lshl_add_u32 v52, v55, 4, v52
  s_waitcnt lgkmcnt(0)
  s_mov_b32 s8, s36
  s_mov_b32 s9, s37
  s_mov_b32 s4, s46
  s_mov_b32 s5, s47
  s_mov_b32 s6, 33554432
  s_mov_b32 s7, 0x20000
  s_load_dwordx2 s[48:49], s[46:47], 0
  s_add_u32 m0, s67, s58
  s_mov_b32 exec_hi, 0x00ffffff
  global_load_lds_dwordx4 v56, s[16:17]
  global_load_lds_dwordx4 v56, s[16:17] offset:896
  s_mov_b32 exec_hi, -1
  s_add_u32 m0, s94, s72
  s_mul_i32 s55, s72, 7
  s_add_u32 s55, s55, s93
  buffer_load_dwordx4 v52, s[8:11], s55 offen lds
  s_add_u32 s72, s72, 1024
  s_cmp_ge_u32 s72, 14336
  s_cselect_b32 s55, 14336, 0
  s_sub_u32 s72, s72, s55
  s_add_u32 m0, s94, s72
  s_mul_i32 s55, s72, 7
  s_add_u32 s55, s55, s93
  buffer_load_dwordx4 v52, s[8:11], s55 offen lds
  s_add_u32 s72, s72, 1024
  s_cmp_ge_u32 s72, 14336
  s_cselect_b32 s55, 14336, 0
  s_sub_u32 s72, s72, s55
  s_add_u32 m0, s67, s59
  s_mov_b32 exec_hi, 0x00ffffff
  global_load_lds_dwordx4 v57, s[16:17]
  global_load_lds_dwordx4 v57, s[16:17] offset:896
  s_mov_b32 exec_hi, -1
  s_add_u32 m0, s94, s72
  s_mul_i32 s55, s72, 7
  s_add_u32 s55, s55, s93
  buffer_load_dwordx4 v52, s[8:11], s55 offen lds
  s_add_u32 s72, s72, 1024
  s_cmp_ge_u32 s72, 14336
  s_cselect_b32 s55, 14336, 0
  s_sub_u32 s72, s72, s55
  s_add_u32 m0, s94, s72
  s_mul_i32 s55, s72, 7
  s_add_u32 s55, s55, s93
  buffer_load_dwordx4 v52, s[8:11], s55 offen lds
  s_add_u32 s72, s72, 1024
  s_cmp_ge_u32 s72, 14336
  s_cselect_b32 s55, 14336, 0
  s_sub_u32 s72, s72, s55
  s_add_u32 m0, s67, s60
  s_mov_b32 exec_hi, 0x00ffffff
  global_load_lds_dwordx4 v58, s[16:17]
  global_load_lds_dwordx4 v58, s[16:17] offset:896
  s_mov_b32 exec_hi, -1
  s_add_u32 m0, s67, s61
  s_mov_b32 exec_hi, 0x00ffffff
  global_load_lds_dwordx4 v59, s[16:17]
  global_load_lds_dwordx4 v59, s[16:17] offset:896
  s_mov_b32 exec_hi, -1
  v_lshlrev_b32 v1, 10, v15
  v_lshl_add_u32 v1, v14, 4, v1
  s_mul_i32 s55, s51, 3328
  s_lshl_b32 s56, s50, 3
  s_add_u32 s55, s55, s56
  s_add_u32 s55, s55, 917504
  v_mul_u32_u24 v3, 26624, v0
  v_add_u32 v3, s55, v3
  s_mul_i32 s90, s50, 26624
  s_add_u32 s90, s90, 917504
  s_mul_i32 s56, s51, 3328
  s_add_u32 s92, s56, s90
  v_lshl_add_u32 v6, v0, 3, s92
  s_lshl_b32 s57, s51, 3
  s_add_u32 s57, s57, s90
  v_mul_u32_u24 v5, 3328, v0
  v_add_u32 v5, s57, v5
  s_mul_i32 s66, s50, 57344
  s_mov_b32 s100, s16
  s_mov_b32 s101, s17
  s_mov_b32 s84, -1
  s_mov_b32 s85, 0
  s_mov_b32 s68, 0x3f803f80
  s_mov_b32 s69, 0x00003f80
  s_mov_b32 s70, 0x3f800000
  s_lshr_b32 s55, s91, 1
  s_lshl_b32 s76, s51, 2
  s_add_u32 s76, s76, s55
  s_mul_i32 s76, s76, 59392
  s_and_b32 s55, s91, 1
  s_lshl_b32 s55, s55, 10
  s_add_u32 s76, s76, s55
  s_add_u32 s76, s76, 11534336
  s_mul_i32 s77, s51, 229376
  s_lshl_b32 s55, s91, 12
  s_add_u32 s77, s77, s55
  s_add_u32 s77, s77, 13631488
  s_mul_i32 s83, s50, 230400
  s_add_u32 s83, s83, s55
  s_add_u32 s83, s83, 16777216
  s_lshl_b32 s55, s51, 15
  s_add_u32 s80, s83, s55
  v_mov_b32 v12, v2
  s_mov_b32 s55, s51
  s_cmp_ge_u32 s55, 7
  s_cselect_b32 s56, 7, 0
  s_sub_u32 s55, s55, s56
  s_lshl_b32 s12, s55, 15
  s_add_u32 s55, s55, 1
  s_cmp_ge_u32 s55, 7
  s_cselect_b32 s56, 7, 0
  s_sub_u32 s55, s55, s56
  s_lshl_b32 s13, s55, 15
  s_add_u32 s55, s55, 1
  s_cmp_ge_u32 s55, 7
  s_cselect_b32 s56, 7, 0
  s_sub_u32 s55, s55, s56
  s_lshl_b32 s14, s55, 15
  s_add_u32 s55, s55, 1
  s_cmp_ge_u32 s55, 7
  s_cselect_b32 s56, 7, 0
  s_sub_u32 s55, s55, s56
  s_lshl_b32 s15, s55, 15
  s_add_u32 s55, s55, 1
  s_cmp_ge_u32 s55, 7
  s_cselect_b32 s56, 7, 0
  s_sub_u32 s55, s55, s56
  s_lshl_b32 s81, s55, 15
  s_add_u32 s55, s55, 1
  s_cmp_ge_u32 s55, 7
  s_cselect_b32 s56, 7, 0
  s_sub_u32 s55, s55, s56
  s_lshl_b32 s82, s55, 15
  s_add_u32 s55, s55, 1
  s_cmp_ge_u32 s55, 7
  s_cselect_b32 s56, 7, 0
  s_sub_u32 s55, s55, s56
  s_lshl_b32 s3, s55, 15
  s_lshl_b32 s57, s51, 1
  s_add_u32 s57, s57, s54
  s_add_u32 s34, s53, 2
  s_mul_i32 s34, s34, 14
  s_add_u32 s34, s34, s57
  s_lshl_b32 s34, s34, 3
  s_add_u32 s34, s34, s90
  s_cmp_eq_u32 s53, 1
  s_cselect_b32 s35, 14, 56
  s_mov_b32 s78, 4294940672
  s_cselect_b32 s78, 26624, s78
  s_cselect_b32 s79, 31, 0
  s_add_u32 s35, s35, s57
  s_lshl_b32 s35, s35, 3
  s_add_u32 s35, s35, s90
  s_add_u32 s35, s35, s78
  s_cmp_eq_u32 s50, s79
  s_cselect_b32 s35, s34, s35
  s_mul_i32 s57, s52, 7
  s_lshr_b32 s57, s57, 1
  s_lshl_b32 s57, s57, 3
  s_add_u32 s57, s57, s92
  s_add_u32 s74, s57, 1376
  s_cmp_eq_u32 s54, 0
  s_cselect_b32 s78, 14, 56
  s_cselect_b32 s79, 0, 31
  s_lshl_b32 s78, s78, 3
  s_add_u32 s75, s57, s78
  s_add_u32 s75, s75, 1152
  s_cmp_eq_u32 s50, s79
  s_cselect_b32 s75, s74, s75
  v_bfe_u32 v55, v0, 2, 2
  v_lshl_add_u32 v34, v15, 3, v55
  v_lshlrev_b32 v34, 7, v34
  v_lshlrev_b32 v55, 1, v55
  v_and_b32 v55, 4, v55
  v_bfe_u32 v64, v0, 4, 1
  v_lshl_or_b32 v55, v64, 1, v55
  v_and_b32 v64, 1, v0
  v_or_b32 v55, v55, v64
  s_lshl_b32 s55, s54, 2
  v_xor_b32 v55, s55, v55
  v_lshl_add_u32 v34, v55, 4, v34
  v_bfe_u32 v64, v0, 1, 1
  v_lshl_add_u32 v34, v64, 3, v34
  v_add_u32 v34, 104448, v34
  s_lshl_b32 s55, s53, 5
  v_add_u32 v64, s55, v14
  v_bfe_u32 v65, v64, 1, 3
  v_mul_u32_u24 v64, 896, v64
  v_add_u32 v64, 47104, v64
  v_xor_b32 v65, v65, v15
  v_lshlrev_b32 v65, 4, v65
  s_mul_i32 s55, s53, 28672
  s_sub_u32 s56, 28672, s55
  v_add_u32 v32, s55, v34
  v_add_u32 v33, s56, v34
  s_add_u32 s55, s55, 47104
  v_add_u32 v35, s55, v2
  v_mov_b32 v36, s68
  v_mov_b32 v37, s68
  v_mov_b32 v38, s68
  v_mov_b32 v39, s68
  s_cmp_eq_u32 s53, 1
  s_movk_i32 s55, 0
  s_cselect_b32 s55, 64, s55
  s_movk_i32 s56, 0
  s_cselect_b32 s56, 384, s56
  v_xor_b32 v55, s55, v65
  v_add3_u32 v24, v55, s56, v64
  s_movk_i32 s55, 32
  s_cselect_b32 s55, 96, s55
  s_movk_i32 s56, 0
  s_cselect_b32 s56, 384, s56
  v_xor_b32 v55, s55, v65
  v_add3_u32 v25, v55, s56, v64
  s_movk_i32 s55, 64
  s_cselect_b32 s55, 0, s55
  s_movk_i32 s56, 0
  s_cselect_b32 s56, 512, s56
  v_xor_b32 v55, s55, v65
  v_add3_u32 v26, v55, s56, v64
  s_movk_i32 s55, 96
  s_cselect_b32 s55, 32, s55
  s_movk_i32 s56, 0
  s_cselect_b32 s56, 512, s56
  v_xor_b32 v55, s55, v65
  v_add3_u32 v27, v55, s56, v64
  s_movk_i32 s55, 64
  s_cselect_b32 s55, 0, s55
  s_movk_i32 s56, 384
  s_cselect_b32 s56, 0, s56
  v_xor_b32 v55, s55, v65
  v_add3_u32 v28, v55, s56, v64
  s_movk_i32 s55, 96
  s_cselect_b32 s55, 32, s55
  s_movk_i32 s56, 384
  s_cselect_b32 s56, 0, s56
  v_xor_b32 v55, s55, v65
  v_add3_u32 v29, v55, s56, v64
  s_movk_i32 s55, 0
  s_cselect_b32 s55, 64, s55
  s_movk_i32 s56, 512
  s_cselect_b32 s56, 0, s56
  v_xor_b32 v55, s55, v65
  v_add3_u32 v30, v55, s56, v64
  s_movk_i32 s55, 32
  s_cselect_b32 s55, 96, s55
  s_movk_i32 s56, 512
  s_cselect_b32 s56, 0, s56
  v_xor_b32 v55, s55, v65
  v_add3_u32 v31, v55, s56, v64
  s_lshl_b32 s55, s54, 6
  s_lshl_b32 s56, s51, 7
  v_xor_b32 v55, s55, v65
  v_add3_u32 v53, v55, s56, v64
  v_xor_b32 v55, 32, v55
  v_add3_u32 v54, v55, s56, v64
  s_lshl_b32 s71, s51, 13
  s_lshl_b32 s55, s54, 12
  s_add_u32 s71, s71, s55
  s_lshl_b32 s55, s53, 9
  s_add_u32 s71, s71, s55
  s_add_u32 s71, s71, s66
  s_add_u32 m0, s67, s62
  s_mov_b32 exec_hi, 0x00ffffff
  global_load_lds_dwordx4 v60, s[16:17]
  global_load_lds_dwordx4 v60, s[16:17] offset:896
  s_mov_b32 exec_hi, -1
  s_add_u32 m0, s67, s63
  s_mov_b32 exec_hi, 0x00ffffff
  global_load_lds_dwordx4 v61, s[16:17]
  global_load_lds_dwordx4 v61, s[16:17] offset:896
  s_mov_b32 exec_hi, -1
  s_add_u32 m0, s67, s64
  s_mov_b32 exec_hi, 0x00ffffff
  global_load_lds_dwordx4 v62, s[16:17]
  global_load_lds_dwordx4 v62, s[16:17] offset:896
  s_mov_b32 exec_hi, -1
  s_add_u32 m0, s67, s65
  s_mov_b32 exec_hi, 0x00ffffff
  global_load_lds_dwordx4 v63, s[16:17]
  global_load_lds_dwordx4 v63, s[16:17] offset:896
  s_mov_b32 exec_hi, -1
  s_add_u32 m0, s94, s72
  s_mul_i32 s55, s72, 7
  s_add_u32 s55, s55, s93
  buffer_load_dwordx4 v52, s[8:11], s55 offen lds
  s_add_u32 s72, s72, 1024
  s_cmp_ge_u32 s72, 14336
  s_cselect_b32 s55, 14336, 0
  s_sub_u32 s72, s72, s55
  s_add_u32 m0, s94, s72
  s_mul_i32 s55, s72, 7
  s_add_u32 s55, s55, s93
  buffer_load_dwordx4 v52, s[8:11], s55 offen lds
  s_add_u32 s72, s72, 1024
  s_cmp_ge_u32 s72, 14336
  s_cselect_b32 s55, 14336, 0
  s_sub_u32 s72, s72, s55
  s_add_u32 m0, s94, s72
  s_mul_i32 s55, s72, 7
  s_add_u32 s55, s55, s93
  buffer_load_dwordx4 v52, s[8:11], s55 offen lds
  s_add_u32 s72, s72, 1024
  s_cmp_ge_u32 s72, 14336
  s_cselect_b32 s55, 14336, 0
  s_sub_u32 s72, s72, s55
  s_add_u32 m0, s94, s72
  s_mul_i32 s55, s72, 7
  s_add_u32 s55, s55, s93
  buffer_load_dwordx4 v52, s[8:11], s55 offen lds
  s_add_u32 s72, s72, 1024
  s_cmp_ge_u32 s72, 14336
  s_cselect_b32 s55, 14336, 0
  s_sub_u32 s72, s72, s55
  s_add_u32 m0, s94, s72
  s_mul_i32 s55, s72, 7
  s_add_u32 s55, s55, s93
  buffer_load_dwordx4 v52, s[8:11], s55 offen lds
  s_add_u32 s72, s72, 1024
  s_cmp_ge_u32 s72, 14336
  s_cselect_b32 s55, 14336, 0
  s_sub_u32 s72, s72, s55
  s_add_u32 m0, s94, s72
  s_mul_i32 s55, s72, 7
  s_add_u32 s55, s55, s93
  buffer_load_dwordx4 v52, s[8:11], s55 offen lds
  s_add_u32 s72, s72, 1024
  s_cmp_ge_u32 s72, 14336
  s_cselect_b32 s55, 14336, 0
  s_sub_u32 s72, s72, s55
  s_add_u32 m0, s94, s72
  s_mul_i32 s55, s72, 7
  s_add_u32 s55, s55, s93
  buffer_load_dwordx4 v52, s[8:11], s55 offen lds
  s_add_u32 s72, s72, 1024
  s_cmp_ge_u32 s72, 14336
  s_cselect_b32 s55, 14336, 0
  s_sub_u32 s72, s72, s55
  s_add_u32 m0, s94, s72
  s_mul_i32 s55, s72, 7
  s_add_u32 s55, s55, s93
  buffer_load_dwordx4 v52, s[8:11], s55 offen lds
  s_add_u32 s72, s72, 1024
  s_cmp_ge_u32 s72, 14336
  s_cselect_b32 s55, 14336, 0
  s_sub_u32 s72, s72, s55
  s_add_u32 m0, s94, s72
  s_mul_i32 s55, s72, 7
  s_add_u32 s55, s55, s93
  buffer_load_dwordx4 v52, s[8:11], s55 offen lds
  s_add_u32 s72, s72, 1024
  s_cmp_ge_u32 s72, 14336
  s_cselect_b32 s55, 14336, 0
  s_sub_u32 s72, s72, s55
  s_add_u32 m0, s94, s72
  s_mul_i32 s55, s72, 7
  s_add_u32 s55, s55, s93
  buffer_load_dwordx4 v52, s[8:11], s55 offen lds
  s_barrier
  s_waitcnt lgkmcnt(0)
  s_add_u32 s48, s48, 1
  s_addc_u32 s49, s49, 0
  v_mov_b32 v8, s48
  v_mov_b32 v9, s49
  v_mov_b32 v112, 0
  v_mov_b32 v113, 0
  v_mov_b32 v114, 0
  v_mov_b32 v115, 0
  v_mov_b32 v116, 0
  v_mov_b32 v117, 0
  v_mov_b32 v118, 0
  v_mov_b32 v119, 0
  v_and_b32 v120, 15, v0
  v_lshrrev_b32 v121, 1, v120
  v_lshrrev_b32 v122, 4, v0
  v_xor_b32 v121, v121, v122
  v_mul_u32_u24 v122, 896, v120
  v_add_u32 v122, s67, v122
  v_lshl_add_u32 v123, v121, 4, v122
  v_xor_b32 v121, 4, v121
  v_lshl_add_u32 v124, v121, 4, v122
  s_lshl_b32 s55, s52, 8
  s_add_u32 s55, s55, 161792
  v_lshl_add_u32 v125, v120, 4, s55
  s_waitcnt vmcnt(10)
  ds_read_b128 v[56:59], v123 offset:0
  ds_read_b128 v[60:63], v124 offset:0
  ds_read_b128 v[64:67], v123 offset:128
  ds_read_b128 v[68:71], v124 offset:128
  ds_read_b128 v[72:75], v123 offset:256
  ds_read_b128 v[76:79], v124 offset:256
  ds_read_b128 v[80:83], v123 offset:384
  ds_read_b128 v[84:87], v124 offset:384
  ds_read_b128 v[88:91], v123 offset:512
  ds_read_b128 v[92:95], v124 offset:512
  ds_read_b128 v[96:99], v123 offset:640
  ds_read_b128 v[100:103], v124 offset:640
  ds_read_b128 v[104:107], v123 offset:768
  ds_read_b128 v[108:111], v124 offset:768
  s_waitcnt lgkmcnt(12)
  v_dot2_f32_bf16 v112, v56, s68, v112
  v_dot2_f32_bf16 v116, v56, v56, v116
  v_dot2_f32_bf16 v113, v57, s68, v113
  v_dot2_f32_bf16 v117, v57, v57, v117
  v_dot2_f32_bf16 v114, v58, s68, v114
  v_dot2_f32_bf16 v118, v58, v58, v118
  v_dot2_f32_bf16 v115, v59, s68, v115
  v_dot2_f32_bf16 v119, v59, v59, v119
  v_dot2_f32_bf16 v112, v60, s68, v112
  v_dot2_f32_bf16 v116, v60, v60, v116
  v_dot2_f32_bf16 v113, v61, s68, v113
  v_dot2_f32_bf16 v117, v61, v61, v117
  v_dot2_f32_bf16 v114, v62, s68, v114
  v_dot2_f32_bf16 v118, v62, v62, v118
  v_dot2_f32_bf16 v115, v63, s68, v115
  v_dot2_f32_bf16 v119, v63, v63, v119
  s_waitcnt lgkmcnt(10)
  v_dot2_f32_bf16 v112, v64, s68, v112
  v_dot2_f32_bf16 v116, v64, v64, v116
  v_dot2_f32_bf16 v113, v65, s68, v113
  v_dot2_f32_bf16 v117, v65, v65, v117
  v_dot2_f32_bf16 v114, v66, s68, v114
  v_dot2_f32_bf16 v118, v66, v66, v118
  v_dot2_f32_bf16 v115, v67, s68, v115
  v_dot2_f32_bf16 v119, v67, v67, v119
  v_dot2_f32_bf16 v112, v68, s68, v112
  v_dot2_f32_bf16 v116, v68, v68, v116
  v_dot2_f32_bf16 v113, v69, s68, v113
  v_dot2_f32_bf16 v117, v69, v69, v117
  v_dot2_f32_bf16 v114, v70, s68, v114
  v_dot2_f32_bf16 v118, v70, v70, v118
  v_dot2_f32_bf16 v115, v71, s68, v115
  v_dot2_f32_bf16 v119, v71, v71, v119
  s_waitcnt lgkmcnt(8)
  v_dot2_f32_bf16 v112, v72, s68, v112
  v_dot2_f32_bf16 v116, v72, v72, v116
  v_dot2_f32_bf16 v113, v73, s68, v113
  v_dot2_f32_bf16 v117, v73, v73, v117
  v_dot2_f32_bf16 v114, v74, s68, v114
  v_dot2_f32_bf16 v118, v74, v74, v118
  v_dot2_f32_bf16 v115, v75, s68, v115
  v_dot2_f32_bf16 v119, v75, v75, v119
  v_dot2_f32_bf16 v112, v76, s68, v112
  v_dot2_f32_bf16 v116, v76, v76, v116
  v_dot2_f32_bf16 v113, v77, s68, v113
  v_dot2_f32_bf16 v117, v77, v77, v117
  v_dot2_f32_bf16 v114, v78, s68, v114
  v_dot2_f32_bf16 v118, v78, v78, v118
  v_dot2_f32_bf16 v115, v79, s68, v115
  v_dot2_f32_bf16 v119, v79, v79, v119
  s_waitcnt lgkmcnt(6)
  v_dot2_f32_bf16 v112, v80, s68, v112
  v_dot2_f32_bf16 v116, v80, v80, v116
  v_dot2_f32_bf16 v113, v81, s68, v113
  v_dot2_f32_bf16 v117, v81, v81, v117
  v_dot2_f32_bf16 v114, v82, s68, v114
  v_dot2_f32_bf16 v118, v82, v82, v118
  v_dot2_f32_bf16 v115, v83, s68, v115
  v_dot2_f32_bf16 v119, v83, v83, v119
  v_dot2_f32_bf16 v112, v84, s68, v112
  v_dot2_f32_bf16 v116, v84, v84, v116
  v_dot2_f32_bf16 v113, v85, s68, v113
  v_dot2_f32_bf16 v117, v85, v85, v117
  v_dot2_f32_bf16 v114, v86, s68, v114
  v_dot2_f32_bf16 v118, v86, v86, v118
  v_dot2_f32_bf16 v115, v87, s68, v115
  v_dot2_f32_bf16 v119, v87, v87, v119
  s_waitcnt lgkmcnt(4)
  v_dot2_f32_bf16 v112, v88, s68, v112
  v_dot2_f32_bf16 v116, v88, v88, v116
  v_dot2_f32_bf16 v113, v89, s68, v113
  v_dot2_f32_bf16 v117, v89, v89, v117
  v_dot2_f32_bf16 v114, v90, s68, v114
  v_dot2_f32_bf16 v118, v90, v90, v118
  v_dot2_f32_bf16 v115, v91, s68, v115
  v_dot2_f32_bf16 v119, v91, v91, v119
  v_dot2_f32_bf16 v112, v92, s68, v112
  v_dot2_f32_bf16 v116, v92, v92, v116
  v_dot2_f32_bf16 v113, v93, s68, v113
  v_dot2_f32_bf16 v117, v93, v93, v117
  v_dot2_f32_bf16 v114, v94, s68, v114
  v_dot2_f32_bf16 v118, v94, v94, v118
  v_dot2_f32_bf16 v115, v95, s68, v115
  v_dot2_f32_bf16 v119, v95, v95, v119
  s_waitcnt lgkmcnt(2)
  v_dot2_f32_bf16 v112, v96, s68, v112
  v_dot2_f32_bf16 v116, v96, v96, v116
  v_dot2_f32_bf16 v113, v97, s68, v113
  v_dot2_f32_bf16 v117, v97, v97, v117
  v_dot2_f32_bf16 v114, v98, s68, v114
  v_dot2_f32_bf16 v118, v98, v98, v118
  v_dot2_f32_bf16 v115, v99, s68, v115
  v_dot2_f32_bf16 v119, v99, v99, v119
  v_dot2_f32_bf16 v112, v100, s68, v112
  v_dot2_f32_bf16 v116, v100, v100, v116
  v_dot2_f32_bf16 v113, v101, s68, v113
  v_dot2_f32_bf16 v117, v101, v101, v117
  v_dot2_f32_bf16 v114, v102, s68, v114
  v_dot2_f32_bf16 v118, v102, v102, v118
  v_dot2_f32_bf16 v115, v103, s68, v115
  v_dot2_f32_bf16 v119, v103, v103, v119
  s_waitcnt lgkmcnt(0)
  v_dot2_f32_bf16 v112, v104, s68, v112
  v_dot2_f32_bf16 v116, v104, v104, v116
  v_dot2_f32_bf16 v113, v105, s68, v113
  v_dot2_f32_bf16 v117, v105, v105, v117
  v_dot2_f32_bf16 v114, v106, s68, v114
  v_dot2_f32_bf16 v118, v106, v106, v118
  v_dot2_f32_bf16 v115, v107, s68, v115
  v_dot2_f32_bf16 v119, v107, v107, v119
  v_dot2_f32_bf16 v112, v108, s68, v112
  v_dot2_f32_bf16 v116, v108, v108, v116
  v_dot2_f32_bf16 v113, v109, s68, v113
  v_dot2_f32_bf16 v117, v109, v109, v117
  v_dot2_f32_bf16 v114, v110, s68, v114
  v_dot2_f32_bf16 v118, v110, v110, v118
  v_dot2_f32_bf16 v115, v111, s68, v115
  v_dot2_f32_bf16 v119, v111, v111, v119
  s_nop 1
  v_pk_add_f32 v[112:113], v[112:113], v[114:115]
  v_pk_add_f32 v[116:117], v[116:117], v[118:119]
  v_add_f32 v112, v112, v113
  v_add_f32 v116, v116, v117
  s_nop 1
  v_permlane32_swap_b32 v112, v116
  v_add_f32 v112, v112, v116
  v_mov_b32 v116, v112
  s_nop 1
  v_permlane16_swap_b32 v112, v116
  v_add_f32 v112, v112, v116
  v_mov_b32 v116, v112
  s_nop 1
  v_permlane32_swap_b32 v112, v116
  v_mul_f32 v130, 0x3b124925, v112
  v_mul_f32 v116, 0x3b124925, v116
  v_fma_f32 v116, -v130, v130, v116
  v_max_f32 v116, 0, v116
  v_cvt_pk_bf16_f32 v113, v116, v116
  v_and_b32 v113, 0xffff0000, v113
  v_add_f32 v113, 0x3727c5ac, v113
  v_cvt_pk_bf16_f32 v113, v113, v113
  v_and_b32 v113, 0xffff0000, v113
  v_sqrt_f32 v113, v113
  s_nop 0
  v_cvt_pk_bf16_f32 v113, v113, v113
  v_and_b32 v113, 0xffff0000, v113
  v_cvt_pk_bf16_f32 v128, v130, v130
  v_and_b32 v128, 0xffff0000, v128
  v_rcp_f32 v129, v113
  s_nop 0
  v_mul_f32 v115, v116, v129
  v_mul_f32 v115, v115, v129
  v_cvt_pk_bf16_f32 v115, v115, v115
  v_and_b32 v115, 0xffff0000, v115
  v_add_f32 v115, 0x3727c5ac, v115
  v_cvt_pk_bf16_f32 v115, v115, v115
  v_and_b32 v115, 0xffff0000, v115
  v_sqrt_f32 v115, v115
  s_nop 0
  v_cvt_pk_bf16_f32 v115, v115, v115
  v_and_b32 v115, 0xffff0000, v115
  v_mul_f32 v131, v113, v115
  ds_write_b128 v125, v[128:131]
  s_waitcnt vmcnt(0)
  s_waitcnt lgkmcnt(0)
  s_barrier
  s_lshl_b32 s55, s53, 9
  s_add_u32 s55, s55, 161792
  v_lshl_add_u32 v55, v14, 4, s55
  ds_read_b128 v[40:43], v55
  ds_read_b128 v[16:19], v53
  ds_read_b128 v[20:23], v54
  ds_read_b128 v[104:107], v24 offset:0
  ds_read_b64_tr_b16 v[108:109], v32 offset:0
  ds_read_b64_tr_b16 v[110:111], v32 offset:512
  ds_read_b128 v[112:115], v25 offset:0
  ds_read_b64_tr_b16 v[116:117], v32 offset:2048
  ds_read_b64_tr_b16 v[118:119], v32 offset:2560
  ds_read_b128 v[120:123], v26 offset:0
  ds_read_b64_tr_b16 v[124:125], v32 offset:4096
  ds_read_b64_tr_b16 v[126:127], v32 offset:4608
  s_waitcnt lgkmcnt(6)
  v_mfma_f32_32x32x16_bf16 v[56:71], v[108:111], v[104:107], 0
  ds_read_b128 v[128:131], v27 offset:0
  ds_read_b64_tr_b16 v[132:133], v32 offset:6144
  ds_read_b64_tr_b16 v[134:135], v32 offset:6656
  v_mfma_f32_32x32x16_bf16 v[72:87], v[108:111], v[36:39], 0
  s_waitcnt lgkmcnt(6)
  v_mfma_f32_32x32x16_bf16 v[56:71], v[116:119], v[112:115], v[56:71]
  ds_read_b128 v[104:107], v24 offset:128
  ds_read_b64_tr_b16 v[108:109], v32 offset:8192
  ds_read_b64_tr_b16 v[110:111], v32 offset:8704
  v_mfma_f32_32x32x16_bf16 v[72:87], v[116:119], v[36:39], v[72:87]
  s_waitcnt lgkmcnt(6)
  v_mfma_f32_32x32x16_bf16 v[56:71], v[124:127], v[120:123], v[56:71]
  ds_read_b128 v[112:115], v25 offset:128
  ds_read_b64_tr_b16 v[116:117], v32 offset:10240
  ds_read_b64_tr_b16 v[118:119], v32 offset:10752
  v_mfma_f32_32x32x16_bf16 v[72:87], v[124:127], v[36:39], v[72:87]
  s_waitcnt lgkmcnt(6)
  v_mfma_f32_32x32x16_bf16 v[56:71], v[132:135], v[128:131], v[56:71]
  ds_read_b128 v[120:123], v26 offset:128
  ds_read_b64_tr_b16 v[124:125], v32 offset:12288
  ds_read_b64_tr_b16 v[126:127], v32 offset:12800
  v_mfma_f32_32x32x16_bf16 v[72:87], v[132:135], v[36:39], v[72:87]
  s_waitcnt lgkmcnt(6)
  v_mfma_f32_32x32x16_bf16 v[56:71], v[108:111], v[104:107], v[56:71]
  ds_read_b128 v[128:131], v27 offset:128
  ds_read_b64_tr_b16 v[132:133], v32 offset:14336
  ds_read_b64_tr_b16 v[134:135], v32 offset:14848
  v_mfma_f32_32x32x16_bf16 v[72:87], v[108:111], v[36:39], v[72:87]
  s_waitcnt lgkmcnt(6)
  v_mfma_f32_32x32x16_bf16 v[56:71], v[116:119], v[112:115], v[56:71]
  ds_read_b128 v[104:107], v24 offset:256
  ds_read_b64_tr_b16 v[108:109], v32 offset:16384
  ds_read_b64_tr_b16 v[110:111], v32 offset:16896
  v_mfma_f32_32x32x16_bf16 v[72:87], v[116:119], v[36:39], v[72:87]
  s_waitcnt lgkmcnt(6)
  v_mfma_f32_32x32x16_bf16 v[56:71], v[124:127], v[120:123], v[56:71]
  ds_read_b128 v[112:115], v25 offset:256
  ds_read_b64_tr_b16 v[116:117], v32 offset:18432
  ds_read_b64_tr_b16 v[118:119], v32 offset:18944
  v_mfma_f32_32x32x16_bf16 v[72:87], v[124:127], v[36:39], v[72:87]
  s_waitcnt lgkmcnt(6)
  v_mfma_f32_32x32x16_bf16 v[56:71], v[132:135], v[128:131], v[56:71]
  ds_read_b128 v[120:123], v26 offset:256
  ds_read_b64_tr_b16 v[124:125], v32 offset:20480
  ds_read_b64_tr_b16 v[126:127], v32 offset:20992
  v_mfma_f32_32x32x16_bf16 v[72:87], v[132:135], v[36:39], v[72:87]
  s_waitcnt lgkmcnt(6)
  v_mfma_f32_32x32x16_bf16 v[56:71], v[108:111], v[104:107], v[56:71]
  ds_read_b128 v[128:131], v27 offset:256
  ds_read_b64_tr_b16 v[132:133], v32 offset:22528
  ds_read_b64_tr_b16 v[134:135], v32 offset:23040
  v_mfma_f32_32x32x16_bf16 v[72:87], v[108:111], v[36:39], v[72:87]
  s_waitcnt lgkmcnt(6)
  v_mfma_f32_32x32x16_bf16 v[56:71], v[116:119], v[112:115], v[56:71]
  ds_read_b128 v[104:107], v24 offset:384
  ds_read_b64_tr_b16 v[108:109], v32 offset:24576
  ds_read_b64_tr_b16 v[110:111], v32 offset:25088
  v_mfma_f32_32x32x16_bf16 v[72:87], v[116:119], v[36:39], v[72:87]
  s_waitcnt lgkmcnt(6)
  v_mfma_f32_32x32x16_bf16 v[56:71], v[124:127], v[120:123], v[56:71]
  ds_read_b128 v[112:115], v25 offset:384
  ds_read_b64_tr_b16 v[116:117], v32 offset:26624
  ds_read_b64_tr_b16 v[118:119], v32 offset:27136
  v_mfma_f32_32x32x16_bf16 v[72:87], v[124:127], v[36:39], v[72:87]
  s_waitcnt lgkmcnt(6)
  v_mfma_f32_32x32x16_bf16 v[56:71], v[132:135], v[128:131], v[56:71]
  ds_read_b128 v[120:123], v28 offset:0
  ds_read_b64_tr_b16 v[124:125], v33 offset:0
  ds_read_b64_tr_b16 v[126:127], v33 offset:512
  v_mfma_f32_32x32x16_bf16 v[72:87], v[132:135], v[36:39], v[72:87]
  s_waitcnt lgkmcnt(6)
  v_mfma_f32_32x32x16_bf16 v[56:71], v[108:111], v[104:107], v[56:71]
  ds_read_b128 v[128:131], v29 offset:0
  ds_read_b64_tr_b16 v[132:133], v33 offset:2048
  ds_read_b64_tr_b16 v[134:135], v33 offset:2560
  v_mfma_f32_32x32x16_bf16 v[72:87], v[108:111], v[36:39], v[72:87]
  s_waitcnt lgkmcnt(6)
  v_mfma_f32_32x32x16_bf16 v[56:71], v[116:119], v[112:115], v[56:71]
  ds_read_b128 v[104:107], v30 offset:0
  ds_read_b64_tr_b16 v[108:109], v33 offset:4096
  ds_read_b64_tr_b16 v[110:111], v33 offset:4608
  v_mfma_f32_32x32x16_bf16 v[72:87], v[116:119], v[36:39], v[72:87]
  s_waitcnt lgkmcnt(6)
  v_mfma_f32_32x32x16_bf16 v[56:71], v[124:127], v[120:123], v[56:71]
  ds_read_b128 v[112:115], v31 offset:0
  ds_read_b64_tr_b16 v[116:117], v33 offset:6144
  ds_read_b64_tr_b16 v[118:119], v33 offset:6656
  s_waitcnt lgkmcnt(6)
  v_mfma_f32_32x32x16_bf16 v[56:71], v[132:135], v[128:131], v[56:71]
  ds_read_b128 v[120:123], v28 offset:128
  ds_read_b64_tr_b16 v[124:125], v33 offset:8192
  ds_read_b64_tr_b16 v[126:127], v33 offset:8704
  s_waitcnt lgkmcnt(6)
  v_mfma_f32_32x32x16_bf16 v[56:71], v[108:111], v[104:107], v[56:71]
  ds_read_b128 v[128:131], v29 offset:128
  ds_read_b64_tr_b16 v[132:133], v33 offset:10240
  ds_read_b64_tr_b16 v[134:135], v33 offset:10752
  s_waitcnt lgkmcnt(6)
  v_mfma_f32_32x32x16_bf16 v[56:71], v[116:119], v[112:115], v[56:71]
  ds_read_b128 v[104:107], v30 offset:128
  ds_read_b64_tr_b16 v[108:109], v33 offset:12288
  ds_read_b64_tr_b16 v[110:111], v33 offset:12800
  s_waitcnt lgkmcnt(6)
  v_mfma_f32_32x32x16_bf16 v[56:71], v[124:127], v[120:123], v[56:71]
  ds_read_b128 v[112:115], v31 offset:128
  ds_read_b64_tr_b16 v[116:117], v33 offset:14336
  ds_read_b64_tr_b16 v[118:119], v33 offset:14848
  s_lshl_b32 s55, s52, 7
  s_add_u32 s55, s55, 162816
  v_lshl_add_u32 v55, v15, 6, s55
  s_mov_b32 exec_lo, 1
  s_mov_b32 exec_hi, 1
  ds_write_b128 v55, v[72:75] offset:0
  ds_write_b128 v55, v[76:79] offset:16
  ds_write_b128 v55, v[80:83] offset:32
  ds_write_b128 v55, v[84:87] offset:48
  s_and_b32 s55, s52, 1
  s_lshl_b32 s55, s55, 2
  s_add_u32 s55, s55, 163408
  s_mov_b64 exec, -1
  v_mov_b32 v10, s55
  v_mov_b32 v11, 1
  s_mov_b64 exec, 1
  ds_add_u32 v10, v11
  s_mov_b64 exec, -1
  v_xor_b32 v55, 0x100, v55
  s_waitcnt lgkmcnt(11)
  v_mfma_f32_32x32x16_bf16 v[56:71], v[132:135], v[128:131], v[56:71]
  ds_read_b128 v[120:123], v28 offset:256
  ds_read_b64_tr_b16 v[124:125], v33 offset:16384
  ds_read_b64_tr_b16 v[126:127], v33 offset:16896
  s_waitcnt lgkmcnt(11)
  v_mfma_f32_32x32x16_bf16 v[56:71], v[108:111], v[104:107], v[56:71]
  ds_read_b128 v[128:131], v29 offset:256
  ds_read_b64_tr_b16 v[132:133], v33 offset:18432
  ds_read_b64_tr_b16 v[134:135], v33 offset:18944
  v_rcp_f32 v46, v43
  v_sub_f32 v44, 0, v42
  v_mov_b32 v50, v43
  v_mul_f32 v48, 0xc0135761, v46
  v_mul_f32 v46, v46, v46
  v_mul_f32 v46, 0x3d372713, v46
  v_mul_f32 v46, v46, v48
  s_add_u32 s33, s71, 2097152
  s_waitcnt lgkmcnt(11)
  v_mfma_f32_32x32x16_bf16 v[56:71], v[116:119], v[112:115], v[56:71]
  ds_read_b128 v[104:107], v30 offset:256
  ds_read_b64_tr_b16 v[108:109], v33 offset:20480
  ds_read_b64_tr_b16 v[110:111], v33 offset:20992
  s_waitcnt lgkmcnt(6)
  v_mfma_f32_32x32x16_bf16 v[56:71], v[124:127], v[120:123], v[56:71]
  ds_read_b128 v[112:115], v31 offset:256
  ds_read_b64_tr_b16 v[116:117], v33 offset:22528
  ds_read_b64_tr_b16 v[118:119], v33 offset:23040
  s_waitcnt lgkmcnt(6)
  v_mfma_f32_32x32x16_bf16 v[56:71], v[132:135], v[128:131], v[56:71]
  ds_read_b128 v[120:123], v28 offset:384
  ds_read_b64_tr_b16 v[124:125], v33 offset:24576
  ds_read_b64_tr_b16 v[126:127], v33 offset:25088
  s_waitcnt lgkmcnt(6)
  v_mfma_f32_32x32x16_bf16 v[56:71], v[108:111], v[104:107], v[56:71]
  ds_read_b128 v[128:131], v29 offset:384
  ds_read_b64_tr_b16 v[132:133], v33 offset:26624
  ds_read_b64_tr_b16 v[134:135], v33 offset:27136
  s_waitcnt lgkmcnt(6)
  v_mfma_f32_32x32x16_bf16 v[56:71], v[116:119], v[112:115], v[56:71]
  s_waitcnt lgkmcnt(3)
  v_mfma_f32_32x32x16_bf16 v[56:71], v[124:127], v[120:123], v[56:71]
  s_waitcnt lgkmcnt(0)
  v_mfma_f32_32x32x16_bf16 v[56:71], v[132:135], v[128:131], v[56:71]
  ds_read_b32 v11, v10
  ds_read_b128 v[88:91], v55 offset:0
  ds_read_b128 v[92:95], v55 offset:16
  ds_read_b128 v[96:99], v55 offset:32
  ds_read_b128 v[100:103], v55 offset:48
  s_waitcnt lgkmcnt(0)
  v_readfirstlane_b32 s55, v11
  s_nop 0
  s_cmp_ge_u32 s55, 2
  s_cbranch_scc1 CSD_12
  s_mov_b32 s96, 400000
LB_13:
  ds_read_b32 v11, v10 offset:0
  s_waitcnt lgkmcnt(0)
  v_readfirstlane_b32 s55, v11
  s_nop 0
  s_cmp_ge_u32 s55, 2
  s_cbranch_scc1 LBD_14
  s_sub_u32 s96, s96, 1
  s_cmp_lg_u32 s96, 0
  s_cbranch_scc1 LB_13
  s_or_b32 s97, s97, 512
LBD_14:
  ds_read_b128 v[88:91], v55 offset:0
  ds_read_b128 v[92:95], v55 offset:16
  ds_read_b128 v[96:99], v55 offset:32
  ds_read_b128 v[100:103], v55 offset:48
  s_waitcnt lgkmcnt(0)
CSD_12:
  v_mov_b32 v10, 163328
  v_mov_b32 v11, 1
  s_mov_b64 exec, 1
  ds_add_u32 v10, v11 offset:8
  s_mov_b64 exec, -1
  v_pk_add_f32 v[72:73], v[72:73], v[88:89]
  v_pk_add_f32 v[74:75], v[74:75], v[90:91]
  v_pk_add_f32 v[76:77], v[76:77], v[92:93]
  v_pk_add_f32 v[78:79], v[78:79], v[94:95]
  v_pk_add_f32 v[80:81], v[80:81], v[96:97]
  v_pk_add_f32 v[82:83], v[82:83], v[98:99]
  v_pk_add_f32 v[84:85], v[84:85], v[100:101]
  v_pk_add_f32 v[86:87], v[86:87], v[102:103]
  v_pk_fma_f32 v[56:57], v[72:73], v[44:45], v[56:57] op_sel_hi:[1,0,1]
  v_pk_fma_f32 v[58:59], v[74:75], v[44:45], v[58:59] op_sel_hi:[1,0,1]
  v_pk_fma_f32 v[60:61], v[76:77], v[44:45], v[60:61] op_sel_hi:[1,0,1]
  v_pk_fma_f32 v[62:63], v[78:79], v[44:45], v[62:63] op_sel_hi:[1,0,1]
  v_pk_fma_f32 v[64:65], v[80:81], v[44:45], v[64:65] op_sel_hi:[1,0,1]
  v_pk_fma_f32 v[66:67], v[82:83], v[44:45], v[66:67] op_sel_hi:[1,0,1]
  v_pk_fma_f32 v[68:69], v[84:85], v[44:45], v[68:69] op_sel_hi:[1,0,1]
  v_pk_fma_f32 v[70:71], v[86:87], v[44:45], v[70:71] op_sel_hi:[1,0,1]
  v_pk_mul_f32 v[104:105], v[56:57], v[56:57]
  v_pk_mul_f32 v[106:107], v[58:59], v[58:59]
  v_pk_mul_f32 v[108:109], v[60:61], v[60:61]
  v_pk_mul_f32 v[110:111], v[62:63], v[62:63]
  v_pk_mul_f32 v[112:113], v[64:65], v[64:65]
  v_pk_mul_f32 v[114:115], v[66:67], v[66:67]
  v_pk_mul_f32 v[116:117], v[68:69], v[68:69]
  v_pk_mul_f32 v[118:119], v[70:71], v[70:71]
  v_pk_fma_f32 v[104:105], v[104:105], v[46:47], v[48:49] op_sel_hi:[1,0,0]
  v_pk_fma_f32 v[106:107], v[106:107], v[46:47], v[48:49] op_sel_hi:[1,0,0]
  v_pk_fma_f32 v[108:109], v[108:109], v[46:47], v[48:49] op_sel_hi:[1,0,0]
  v_pk_fma_f32 v[110:111], v[110:111], v[46:47], v[48:49] op_sel_hi:[1,0,0]
  v_pk_fma_f32 v[112:113], v[112:113], v[46:47], v[48:49] op_sel_hi:[1,0,0]
  v_pk_fma_f32 v[114:115], v[114:115], v[46:47], v[48:49] op_sel_hi:[1,0,0]
  v_pk_fma_f32 v[116:117], v[116:117], v[46:47], v[48:49] op_sel_hi:[1,0,0]
  v_pk_fma_f32 v[118:119], v[118:119], v[46:47], v[48:49] op_sel_hi:[1,0,0]
  v_pk_mul_f32 v[104:105], v[104:105], v[56:57]
  v_pk_mul_f32 v[106:107], v[106:107], v[58:59]
  v_pk_mul_f32 v[108:109], v[108:109], v[60:61]
  v_pk_mul_f32 v[110:111], v[110:111], v[62:63]
  v_pk_mul_f32 v[112:113], v[112:113], v[64:65]
  v_pk_mul_f32 v[114:115], v[114:115], v[66:67]
  v_pk_mul_f32 v[116:117], v[116:117], v[68:69]
  v_pk_mul_f32 v[118:119], v[118:119], v[70:71]
  v_exp_f32 v104, v104
  v_exp_f32 v105, v105
  v_exp_f32 v106, v106
  v_exp_f32 v107, v107
  v_exp_f32 v108, v108
  v_exp_f32 v109, v109
  v_exp_f32 v110, v110
  v_exp_f32 v111, v111
  v_exp_f32 v112, v112
  v_exp_f32 v113, v113
  v_exp_f32 v114, v114
  v_exp_f32 v115, v115
  v_exp_f32 v116, v116
  v_exp_f32 v117, v117
  v_exp_f32 v118, v118
  v_exp_f32 v119, v119
  v_pk_fma_f32 v[104:105], v[104:105], v[50:51], v[50:51] op_sel_hi:[1,0,0]
  v_pk_fma_f32 v[106:107], v[106:107], v[50:51], v[50:51] op_sel_hi:[1,0,0]
  v_pk_fma_f32 v[108:109], v[108:109], v[50:51], v[50:51] op_sel_hi:[1,0,0]
  v_pk_fma_f32 v[110:111], v[110:111], v[50:51], v[50:51] op_sel_hi:[1,0,0]
  v_pk_fma_f32 v[112:113], v[112:113], v[50:51], v[50:51] op_sel_hi:[1,0,0]
  v_pk_fma_f32 v[114:115], v[114:115], v[50:51], v[50:51] op_sel_hi:[1,0,0]
  v_pk_fma_f32 v[116:117], v[116:117], v[50:51], v[50:51] op_sel_hi:[1,0,0]
  v_pk_fma_f32 v[118:119], v[118:119], v[50:51], v[50:51] op_sel_hi:[1,0,0]
  v_rcp_f32 v104, v104
  v_rcp_f32 v105, v105
  v_rcp_f32 v106, v106
  v_rcp_f32 v107, v107
  v_rcp_f32 v108, v108
  v_rcp_f32 v109, v109
  v_rcp_f32 v110, v110
  v_rcp_f32 v111, v111
  v_rcp_f32 v112, v112
  v_rcp_f32 v113, v113
  v_rcp_f32 v114, v114
  v_rcp_f32 v115, v115
  v_rcp_f32 v116, v116
  v_rcp_f32 v117, v117
  v_rcp_f32 v118, v118
  v_rcp_f32 v119, v119
  v_pk_mul_f32 v[104:105], v[104:105], v[56:57]
  v_pk_mul_f32 v[106:107], v[106:107], v[58:59]
  v_pk_mul_f32 v[108:109], v[108:109], v[60:61]
  v_pk_mul_f32 v[110:111], v[110:111], v[62:63]
  v_pk_mul_f32 v[112:113], v[112:113], v[64:65]
  v_pk_mul_f32 v[114:115], v[114:115], v[66:67]
  v_pk_mul_f32 v[116:117], v[116:117], v[68:69]
  v_pk_mul_f32 v[118:119], v[118:119], v[70:71]
  v_cvt_pk_bf16_f32 v120, v104, v105
  v_cvt_pk_bf16_f32 v121, v106, v107
  v_cvt_pk_bf16_f32 v122, v108, v109
  v_cvt_pk_bf16_f32 v123, v110, v111
  v_cvt_pk_bf16_f32 v124, v112, v113
  v_cvt_pk_bf16_f32 v125, v114, v115
  v_cvt_pk_bf16_f32 v126, v116, v117
  v_cvt_pk_bf16_f32 v127, v118, v119
  buffer_store_dwordx4 v[120:123], v1, s[4:7], s33 offen sc1
  buffer_store_dwordx4 v[124:127], v1, s[4:7], s33 offen offset:2048 sc1
  v_mov_b32 v10, 163328
  s_mov_b32 s96, 400000
LB_15:
  ds_read_b32 v11, v10 offset:8
  s_waitcnt lgkmcnt(0)
  v_readfirstlane_b32 s55, v11
  s_nop 0
  s_cmp_ge_u32 s55, 4
  s_cbranch_scc1 LBD_16
  s_sub_u32 s96, s96, 1
  s_cmp_lg_u32 s96, 0
  s_cbranch_scc1 LB_15
  s_or_b32 s97, s97, 512
LBD_16:
  s_mov_b32 s8, s38
  s_mov_b32 s9, s39
  s_mov_b32 m0, s94
  s_lshl_b32 s55, s52, 2
  s_add_u32 s55, s55, 163392
  v_mov_b32 v10, s55
  ds_read_b32 v11, v10
  v_mov_b32 v50, 163328
  ds_read_b32 v51, v50 offset:56
  s_mul_i32 s55, s52, 3072
  s_add_u32 s55, s55, 34816
  v_add_u32 v37, s55, v2
  buffer_load_dwordx4 v52, s[8:11], s93 offen lds
  s_add_u32 s93, s93, 7168
  s_add_u32 m0, m0, 1024
  s_nop 0
  buffer_load_dwordx4 v52, s[8:11], s93 offen lds
  s_add_u32 s93, s93, 7168
  s_add_u32 m0, m0, 1024
  s_nop 0
  buffer_load_dwordx4 v52, s[8:11], s93 offen lds
  s_add_u32 s93, s93, 7168
  s_add_u32 m0, m0, 1024
  s_nop 0
  buffer_load_dwordx4 v52, s[8:11], s93 offen lds
  s_add_u32 s93, s93, 7168
  s_add_u32 m0, m0, 1024
  s_nop 0
  buffer_load_dwordx4 v52, s[8:11], s93 offen lds
  s_add_u32 s93, s93, 7168
  s_add_u32 m0, m0, 1024
  s_nop 0
  buffer_load_dwordx4 v52, s[8:11], s93 offen lds
  s_add_u32 s93, s93, 7168
  s_add_u32 m0, m0, 1024
  s_nop 0
  buffer_load_dwordx4 v52, s[8:11], s93 offen lds
  s_add_u32 s93, s93, 7168
  s_add_u32 m0, m0, 1024
  s_nop 0
  buffer_load_dwordx4 v52, s[8:11], s93 offen lds
  s_add_u32 s93, s93, 7168
  s_add_u32 m0, m0, 1024
  s_mov_b32 s60, m0
  s_waitcnt lgkmcnt(0)
  v_readfirstlane_b32 s55, v11
  s_nop 0
  s_cmp_ge_u32 s55, 1
  s_cbranch_scc1 LBD_18
  s_mov_b32 s96, 400000
LB_17:
  ds_read_b32 v11, v10 offset:0
  s_waitcnt lgkmcnt(0)
  v_readfirstlane_b32 s55, v11
  s_nop 0
  s_cmp_ge_u32 s55, 1
  s_cbranch_scc1 LBD_18
  s_sub_u32 s96, s96, 1
  s_cmp_lg_u32 s96, 0
  s_cbranch_scc1 LB_17
  s_or_b32 s97, s97, 512
LBD_18:
  s_waitcnt lgkmcnt(0)
  v_readfirstlane_b32 s55, v51
  s_nop 0
  s_cmp_ge_u32 s55, 4
  s_cbranch_scc1 LBD_20
  s_mov_b32 s96, 400000
LB_19:
  ds_read_b32 v51, v50 offset:56
  s_waitcnt lgkmcnt(0)
  v_readfirstlane_b32 s55, v51
  s_nop 0
  s_cmp_ge_u32 s55, 4
  s_cbranch_scc1 LBD_20
  s_sub_u32 s96, s96, 1
  s_cmp_lg_u32 s96, 0
  s_cbranch_scc1 LB_19
  s_or_b32 s97, s97, 512
LBD_20:
  ds_read_b128 v[30:33], v37
  s_mul_i32 s73, s52, 7168
  s_add_u32 s73, s73, 47104
  v_mul_u32_u24 v36, 272, v14
  v_add_u32 v55, 21760, v36
  v_cmp_lt_u32 vcc, 25, v14
  s_nop 1
  v_cndmask_b32 v36, v36, v55, vcc
  v_lshl_add_u32 v36, v15, 4, v36
  v_add_u32 v36, s73, v36
  s_sub_u32 s73, s73, 32768
  v_and_b32 v55, 7, v0
  v_mul_u32_u24 v55, 3328, v55
  v_mov_b32 v53, s34
  v_mov_b32 v54, s35
  v_cmp_gt_u32 vcc, 8, v0
  s_nop 1
  v_cndmask_b32 v53, v54, v53, vcc
  v_add_u32 v55, v55, v53
  s_waitcnt lgkmcnt(0)
  s_mov_b32 m0, s73
  v_mov_b32 v88, v32
  v_mov_b32 v89, v33
  v_mul_f32 v96, 0x41000000, v88
  v_mul_f32 v97, 0x41000000, v89
  v_mul_f32 v98, 0x43800000, v88
  v_mul_f32 v99, 0x43800000, v89
  v_fract_f32 v89, v89
  v_fract_f32 v97, v97
  v_fract_f32 v99, v99
  v_exp_f32 v96, v96
  v_cos_f32 v92, v97
  v_sin_f32 v93, v97
  v_exp_f32 v88, v88
  v_cos_f32 v26, v89
  v_sin_f32 v27, v89
  v_exp_f32 v98, v98
  v_cos_f32 v28, v99
  v_sin_f32 v29, v99
  v_pk_mul_f32 v[92:93], v[92:93], v[96:97] op_sel_hi:[1,0]
  v_pk_mul_f32 v[26:27], v[26:27], v[88:89] op_sel_hi:[1,0]
  v_pk_mul_f32 v[28:29], v[28:29], v[98:99] op_sel_hi:[1,0]
  v_mov_b32 v96, 1.0
  v_mov_b32 v97, 0
  v_mov_b32 v98, v92
  v_mov_b32 v99, v93
  v_pk_mul_f32 v[100:101], v[92:93], v[92:93] op_sel_hi:[1,0]
  v_pk_mul_f32 v[24:25], v[26:27], v[26:27] op_sel_hi:[1,0]
  v_pk_fma_f32 v[100:101], v[92:93], v[92:93], v[100:101] op_sel:[1,1,0] op_sel_hi:[0,1,1] neg_lo:[1,0,0]
  v_pk_fma_f32 v[24:25], v[26:27], v[26:27], v[24:25] op_sel:[1,1,0] op_sel_hi:[0,1,1] neg_lo:[1,0,0]
  v_pk_mul_f32 v[102:103], v[100:101], v[92:93] op_sel_hi:[1,0]
  v_pk_mul_f32 v[112:113], v[100:101], v[100:101] op_sel_hi:[1,0]
  v_pk_fma_f32 v[102:103], v[100:101], v[92:93], v[102:103] op_sel:[1,1,0] op_sel_hi:[0,1,1] neg_lo:[1,0,0]
  v_pk_fma_f32 v[112:113], v[100:101], v[100:101], v[112:113] op_sel:[1,1,0] op_sel_hi:[0,1,1] neg_lo:[1,0,0]
  v_pk_mul_f32 v[104:105], v[96:97], v[112:113] op_sel_hi:[1,0]
  v_cvt_pk_f16_f32 v114, v96, v97
  v_pk_mul_f32 v[106:107], v[98:99], v[112:113] op_sel_hi:[1,0]
  v_cvt_pk_f16_f32 v115, v98, v99
  v_pk_mul_f32 v[108:109], v[100:101], v[112:113] op_sel_hi:[1,0]
  v_cvt_pk_f16_f32 v116, v100, v101
  v_pk_mul_f32 v[110:111], v[102:103], v[112:113] op_sel_hi:[1,0]
  v_cvt_pk_f16_f32 v117, v102, v103
  v_pk_fma_f32 v[104:105], v[96:97], v[112:113], v[104:105] op_sel:[1,1,0] op_sel_hi:[0,1,1] neg_lo:[1,0,0]
  ds_write_addtid_b32 v114 offset:32768
  v_pk_fma_f32 v[106:107], v[98:99], v[112:113], v[106:107] op_sel:[1,1,0] op_sel_hi:[0,1,1] neg_lo:[1,0,0]
  ds_write_addtid_b32 v115 offset:33040
  v_pk_fma_f32 v[108:109], v[100:101], v[112:113], v[108:109] op_sel:[1,1,0] op_sel_hi:[0,1,1] neg_lo:[1,0,0]
  ds_write_addtid_b32 v116 offset:33312
  v_pk_fma_f32 v[110:111], v[102:103], v[112:113], v[110:111] op_sel:[1,1,0] op_sel_hi:[0,1,1] neg_lo:[1,0,0]
  ds_write_addtid_b32 v117 offset:33584
  v_pk_mul_f32 v[96:97], v[104:105], v[112:113] op_sel_hi:[1,0]
  v_cvt_pk_f16_f32 v114, v104, v105
  v_pk_mul_f32 v[98:99], v[106:107], v[112:113] op_sel_hi:[1,0]
  v_cvt_pk_f16_f32 v115, v106, v107
  v_pk_mul_f32 v[100:101], v[108:109], v[112:113] op_sel_hi:[1,0]
  v_cvt_pk_f16_f32 v116, v108, v109
  v_pk_mul_f32 v[102:103], v[110:111], v[112:113] op_sel_hi:[1,0]
  v_cvt_pk_f16_f32 v117, v110, v111
  v_pk_fma_f32 v[96:97], v[104:105], v[112:113], v[96:97] op_sel:[1,1,0] op_sel_hi:[0,1,1] neg_lo:[1,0,0]
  ds_write_addtid_b32 v114 offset:33856
  v_pk_fma_f32 v[98:99], v[106:107], v[112:113], v[98:99] op_sel:[1,1,0] op_sel_hi:[0,1,1] neg_lo:[1,0,0]
  ds_write_addtid_b32 v115 offset:34128
  v_pk_fma_f32 v[100:101], v[108:109], v[112:113], v[100:101] op_sel:[1,1,0] op_sel_hi:[0,1,1] neg_lo:[1,0,0]
  ds_write_addtid_b32 v116 offset:34400
  v_pk_fma_f32 v[102:103], v[110:111], v[112:113], v[102:103] op_sel:[1,1,0] op_sel_hi:[0,1,1] neg_lo:[1,0,0]
  ds_write_addtid_b32 v117 offset:34672
  s_waitcnt vmcnt(8)
  s_mov_b64 exec, 0x7f7f
  buffer_store_dwordx2 v[8:9], v55, s[4:7], 0 offen offset:1152 sc1
  s_mov_b64 exec, -1
  s_mov_b32 m0, s73
  v_pk_mul_f32 v[104:105], v[96:97], v[112:113] op_sel_hi:[1,0]
  v_cvt_pk_f16_f32 v114, v96, v97
  v_pk_mul_f32 v[106:107], v[98:99], v[112:113] op_sel_hi:[1,0]
  v_cvt_pk_f16_f32 v115, v98, v99
  v_pk_mul_f32 v[108:109], v[100:101], v[112:113] op_sel_hi:[1,0]
  v_cvt_pk_f16_f32 v116, v100, v101
  v_pk_mul_f32 v[110:111], v[102:103], v[112:113] op_sel_hi:[1,0]
  v_cvt_pk_f16_f32 v117, v102, v103
  v_pk_fma_f32 v[104:105], v[96:97], v[112:113], v[104:105] op_sel:[1,1,0] op_sel_hi:[0,1,1] neg_lo:[1,0,0]
  ds_write_addtid_b32 v114 offset:34944
  v_pk_fma_f32 v[106:107], v[98:99], v[112:113], v[106:107] op_sel:[1,1,0] op_sel_hi:[0,1,1] neg_lo:[1,0,0]
  ds_write_addtid_b32 v115 offset:35216
  v_pk_fma_f32 v[108:109], v[100:101], v[112:113], v[108:109] op_sel:[1,1,0] op_sel_hi:[0,1,1] neg_lo:[1,0,0]
  ds_write_addtid_b32 v116 offset:35488
  v_pk_fma_f32 v[110:111], v[102:103], v[112:113], v[110:111] op_sel:[1,1,0] op_sel_hi:[0,1,1] neg_lo:[1,0,0]
  ds_write_addtid_b32 v117 offset:35760
  v_pk_mul_f32 v[96:97], v[104:105], v[112:113] op_sel_hi:[1,0]
  v_cvt_pk_f16_f32 v114, v104, v105
  v_pk_mul_f32 v[98:99], v[106:107], v[112:113] op_sel_hi:[1,0]
  v_cvt_pk_f16_f32 v115, v106, v107
  v_pk_mul_f32 v[100:101], v[108:109], v[112:113] op_sel_hi:[1,0]
  v_cvt_pk_f16_f32 v116, v108, v109
  v_pk_mul_f32 v[102:103], v[110:111], v[112:113] op_sel_hi:[1,0]
  v_cvt_pk_f16_f32 v117, v110, v111
  v_pk_fma_f32 v[96:97], v[104:105], v[112:113], v[96:97] op_sel:[1,1,0] op_sel_hi:[0,1,1] neg_lo:[1,0,0]
  ds_write_addtid_b32 v114 offset:36032
  v_pk_fma_f32 v[98:99], v[106:107], v[112:113], v[98:99] op_sel:[1,1,0] op_sel_hi:[0,1,1] neg_lo:[1,0,0]
  ds_write_addtid_b32 v115 offset:36304
  v_pk_fma_f32 v[100:101], v[108:109], v[112:113], v[100:101] op_sel:[1,1,0] op_sel_hi:[0,1,1] neg_lo:[1,0,0]
  ds_write_addtid_b32 v116 offset:36576
  v_pk_fma_f32 v[102:103], v[110:111], v[112:113], v[102:103] op_sel:[1,1,0] op_sel_hi:[0,1,1] neg_lo:[1,0,0]
  ds_write_addtid_b32 v117 offset:36848
  v_pk_mul_f32 v[104:105], v[96:97], v[112:113] op_sel_hi:[1,0]
  v_cvt_pk_f16_f32 v114, v96, v97
  v_pk_mul_f32 v[106:107], v[98:99], v[112:113] op_sel_hi:[1,0]
  v_cvt_pk_f16_f32 v115, v98, v99
  v_pk_mul_f32 v[108:109], v[100:101], v[112:113] op_sel_hi:[1,0]
  v_cvt_pk_f16_f32 v116, v100, v101
  v_pk_mul_f32 v[110:111], v[102:103], v[112:113] op_sel_hi:[1,0]
  v_cvt_pk_f16_f32 v117, v102, v103
  v_pk_fma_f32 v[104:105], v[96:97], v[112:113], v[104:105] op_sel:[1,1,0] op_sel_hi:[0,1,1] neg_lo:[1,0,0]
  ds_write_addtid_b32 v114 offset:37120
  v_pk_fma_f32 v[106:107], v[98:99], v[112:113], v[106:107] op_sel:[1,1,0] op_sel_hi:[0,1,1] neg_lo:[1,0,0]
  ds_write_addtid_b32 v115 offset:37392
  v_pk_fma_f32 v[108:109], v[100:101], v[112:113], v[108:109] op_sel:[1,1,0] op_sel_hi:[0,1,1] neg_lo:[1,0,0]
  ds_write_addtid_b32 v116 offset:37664
  v_pk_fma_f32 v[110:111], v[102:103], v[112:113], v[110:111] op_sel:[1,1,0] op_sel_hi:[0,1,1] neg_lo:[1,0,0]
  ds_write_addtid_b32 v117 offset:37936
  v_pk_mul_f32 v[96:97], v[104:105], v[112:113] op_sel_hi:[1,0]
  v_cvt_pk_f16_f32 v114, v104, v105
  v_pk_mul_f32 v[98:99], v[106:107], v[112:113] op_sel_hi:[1,0]
  v_cvt_pk_f16_f32 v115, v106, v107
  v_pk_mul_f32 v[100:101], v[108:109], v[112:113] op_sel_hi:[1,0]
  v_cvt_pk_f16_f32 v116, v108, v109
  v_pk_mul_f32 v[102:103], v[110:111], v[112:113] op_sel_hi:[1,0]
  v_cvt_pk_f16_f32 v117, v110, v111
  v_pk_fma_f32 v[96:97], v[104:105], v[112:113], v[96:97] op_sel:[1,1,0] op_sel_hi:[0,1,1] neg_lo:[1,0,0]
  ds_write_addtid_b32 v114 offset:38208
  v_pk_fma_f32 v[98:99], v[106:107], v[112:113], v[98:99] op_sel:[1,1,0] op_sel_hi:[0,1,1] neg_lo:[1,0,0]
  ds_write_addtid_b32 v115 offset:38480
  v_pk_fma_f32 v[100:101], v[108:109], v[112:113], v[100:101] op_sel:[1,1,0] op_sel_hi:[0,1,1] neg_lo:[1,0,0]
  ds_write_addtid_b32 v116 offset:38752
  v_pk_fma_f32 v[102:103], v[110:111], v[112:113], v[102:103] op_sel:[1,1,0] op_sel_hi:[0,1,1] neg_lo:[1,0,0]
  ds_write_addtid_b32 v117 offset:39024
  v_pk_mul_f32 v[104:105], v[96:97], v[112:113] op_sel_hi:[1,0]
  v_cvt_pk_f16_f32 v114, v96, v97
  v_pk_mul_f32 v[106:107], v[98:99], v[112:113] op_sel_hi:[1,0]
  v_cvt_pk_f16_f32 v115, v98, v99
  v_pk_mul_f32 v[108:109], v[100:101], v[112:113] op_sel_hi:[1,0]
  v_cvt_pk_f16_f32 v116, v100, v101
  v_pk_mul_f32 v[110:111], v[102:103], v[112:113] op_sel_hi:[1,0]
  v_cvt_pk_f16_f32 v117, v102, v103
  v_pk_fma_f32 v[104:105], v[96:97], v[112:113], v[104:105] op_sel:[1,1,0] op_sel_hi:[0,1,1] neg_lo:[1,0,0]
  ds_write_addtid_b32 v114 offset:39296
  v_pk_fma_f32 v[106:107], v[98:99], v[112:113], v[106:107] op_sel:[1,1,0] op_sel_hi:[0,1,1] neg_lo:[1,0,0]
  ds_write_addtid_b32 v115 offset:39568
  v_pk_fma_f32 v[108:109], v[100:101], v[112:113], v[108:109] op_sel:[1,1,0] op_sel_hi:[0,1,1] neg_lo:[1,0,0]
  ds_write_addtid_b32 v116 offset:61600
  v_pk_fma_f32 v[110:111], v[102:103], v[112:113], v[110:111] op_sel:[1,1,0] op_sel_hi:[0,1,1] neg_lo:[1,0,0]
  ds_write_addtid_b32 v117 offset:61872
  v_cvt_pk_f16_f32 v114, v104, v105
  v_cvt_pk_f16_f32 v115, v106, v107
  v_cvt_pk_f16_f32 v116, v108, v109
  v_cvt_pk_f16_f32 v117, v110, v111
  ds_write_addtid_b32 v114 offset:62144
  ds_write_addtid_b32 v115 offset:62416
  ds_write_addtid_b32 v116 offset:62688
  ds_write_addtid_b32 v117 offset:62960
  ds_read_b128 v[56:59], v36 offset:0
  ds_read_b128 v[60:63], v36 offset:32
  ds_read_b128 v[64:67], v36 offset:64
  ds_read_b128 v[68:71], v36 offset:96
  ds_read_b128 v[72:75], v36 offset:128
  ds_read_b128 v[76:79], v36 offset:160
  ds_read_b128 v[80:83], v36 offset:192
  ds_read_b128 v[84:87], v36 offset:224
  v_pk_mul_f32 v[96:97], v[30:31], v[26:27] op_sel_hi:[1,0]
  v_pk_mul_f32 v[98:99], v[30:31], v[24:25] op_sel_hi:[1,0]
  v_pk_fma_f32 v[96:97], v[30:31], v[26:27], v[96:97] op_sel:[1,1,0] op_sel_hi:[0,1,1] neg_lo:[1,0,0]
  v_pk_fma_f32 v[98:99], v[30:31], v[24:25], v[98:99] op_sel:[1,1,0] op_sel_hi:[0,1,1] neg_lo:[1,0,0]
  v_cvt_pk_f16_f32 v114, v30, -v31
  ds_write_addtid_b32 v114 offset:32768
  v_pk_mul_f32 v[100:101], v[96:97], v[24:25] op_sel_hi:[1,0]
  v_pk_mul_f32 v[102:103], v[98:99], v[24:25] op_sel_hi:[1,0]
  v_pk_fma_f32 v[100:101], v[96:97], v[24:25], v[100:101] op_sel:[1,1,0] op_sel_hi:[0,1,1] neg_lo:[1,0,0]
  v_pk_fma_f32 v[102:103], v[98:99], v[24:25], v[102:103] op_sel:[1,1,0] op_sel_hi:[0,1,1] neg_lo:[1,0,0]
  v_cvt_pk_f16_f32 v115, v96, -v97
  ds_write_addtid_b32 v115 offset:33040
  v_cvt_pk_f16_f32 v116, v98, -v99
  ds_write_addtid_b32 v116 offset:33312
  v_pk_mul_f32 v[104:105], v[100:101], v[24:25] op_sel_hi:[1,0]
  v_pk_mul_f32 v[106:107], v[102:103], v[24:25] op_sel_hi:[1,0]
  v_pk_fma_f32 v[104:105], v[100:101], v[24:25], v[104:105] op_sel:[1,1,0] op_sel_hi:[0,1,1] neg_lo:[1,0,0]
  v_pk_fma_f32 v[106:107], v[102:103], v[24:25], v[106:107] op_sel:[1,1,0] op_sel_hi:[0,1,1] neg_lo:[1,0,0]
  v_cvt_pk_f16_f32 v117, v100, -v101
  ds_write_addtid_b32 v117 offset:33584
  v_cvt_pk_f16_f32 v114, v102, -v103
  ds_write_addtid_b32 v114 offset:34944
  v_pk_mul_f32 v[108:109], v[104:105], v[24:25] op_sel_hi:[1,0]
  v_pk_mul_f32 v[110:111], v[106:107], v[24:25] op_sel_hi:[1,0]
  v_pk_fma_f32 v[108:109], v[104:105], v[24:25], v[108:109] op_sel:[1,1,0] op_sel_hi:[0,1,1] neg_lo:[1,0,0]
  v_pk_fma_f32 v[110:111], v[106:107], v[24:25], v[110:111] op_sel:[1,1,0] op_sel_hi:[0,1,1] neg_lo:[1,0,0]
  v_cvt_pk_f16_f32 v115, v104, -v105
  ds_write_addtid_b32 v115 offset:35216
  v_cvt_pk_f16_f32 v116, v106, -v107
  ds_write_addtid_b32 v116 offset:35488
  v_cvt_pk_f16_f32 v117, v108, -v109
  ds_write_addtid_b32 v117 offset:35760
  s_add_u32 s55, s53, 1
  s_sub_u32 s56, 0, s55
  s_cmp_eq_u32 s54, 0
  s_cselect_b32 s55, s56, s55
  s_lshl_b32 s56, s50, 6
  s_add_u32 s55, s55, s56
  s_mov_b32 s57, 57344
  v_mov_b32 v44, 0x80000000
  v_add_u32 v38, s55, v14
  v_lshrrev_b32 v53, 6, v38
  v_mul_u32_u24 v53, s57, v53
  v_and_b32 v39, 63, v38
  v_lshl_add_u32 v53, v39, 4, v53
  v_lshl_add_u32 v53, v15, 10, v53
  v_cmp_gt_u32 vcc, 0x800, v38
  s_nop 1
  v_cndmask_b32 v53, v44, v53, vcc
  s_add_u32 s55, s55, 32
  v_add_u32 v38, s55, v14
  v_lshrrev_b32 v54, 6, v38
  v_mul_u32_u24 v54, s57, v54
  v_and_b32 v39, 63, v38
  v_lshl_add_u32 v54, v39, 4, v54
  v_lshl_add_u32 v54, v15, 10, v54
  v_cmp_gt_u32 vcc, 0x800, v38
  s_nop 1
  v_cndmask_b32 v54, v44, v54, vcc
  s_mul_i32 s78, s52, 14336
  s_add_u32 s78, s78, 2097152
  s_mul_i32 s79, s52, 7168
  s_add_u32 s79, s79, 47104
  s_mov_b32 m0, s73
  v_pk_mul_f32 v[96:97], v[30:31], v[28:29] op_sel_hi:[1,0]
  v_pk_mul_f32 v[104:105], v[110:111], v[28:29] op_sel_hi:[1,0]
  v_pk_mul_f32 v[88:89], v[102:103], v[28:29] op_sel_hi:[1,0]
  v_pk_mul_f32 v[92:93], v[98:99], v[28:29] op_sel_hi:[1,0]
  v_pk_mul_f32 v[112:113], v[106:107], v[28:29] op_sel_hi:[1,0]
  v_pk_fma_f32 v[96:97], v[30:31], v[28:29], v[96:97] op_sel:[1,1,0] op_sel_hi:[0,1,1] neg_lo:[1,0,0]
  v_pk_fma_f32 v[104:105], v[110:111], v[28:29], v[104:105] op_sel:[1,1,0] op_sel_hi:[0,1,1] neg_lo:[1,0,0]
  v_pk_fma_f32 v[88:89], v[102:103], v[28:29], v[88:89] op_sel:[1,1,0] op_sel_hi:[0,1,1] neg_lo:[1,0,0]
  v_pk_fma_f32 v[92:93], v[98:99], v[28:29], v[92:93] op_sel:[1,1,0] op_sel_hi:[0,1,1] neg_lo:[1,0,0]
  v_pk_fma_f32 v[112:113], v[106:107], v[28:29], v[112:113] op_sel:[1,1,0] op_sel_hi:[0,1,1] neg_lo:[1,0,0]
  v_cvt_pk_f16_f32 v114, v96, -v97
  ds_write_addtid_b32 v114 offset:33856
  ds_write_addtid_b32 v114 offset:34128
  v_cvt_pk_f16_f32 v115, v92, -v93
  ds_write_addtid_b32 v115 offset:34400
  v_cvt_pk_f16_f32 v116, v88, -v89
  ds_write_addtid_b32 v116 offset:34672
  ds_write_addtid_b32 v116 offset:36032
  ds_write_addtid_b32 v116 offset:36304
  v_cvt_pk_f16_f32 v117, v112, -v113
  ds_write_addtid_b32 v117 offset:36576
  v_cvt_pk_f16_f32 v114, v104, -v105
  ds_write_addtid_b32 v114 offset:36848
  v_pk_mul_f32 v[100:101], v[96:97], v[28:29] op_sel_hi:[1,0]
  v_pk_mul_f32 v[108:109], v[104:105], v[28:29] op_sel_hi:[1,0]
  v_pk_mul_f32 v[90:91], v[88:89], v[28:29] op_sel_hi:[1,0]
  v_pk_fma_f32 v[100:101], v[96:97], v[28:29], v[100:101] op_sel:[1,1,0] op_sel_hi:[0,1,1] neg_lo:[1,0,0]
  v_pk_fma_f32 v[108:109], v[104:105], v[28:29], v[108:109] op_sel:[1,1,0] op_sel_hi:[0,1,1] neg_lo:[1,0,0]
  v_pk_fma_f32 v[90:91], v[88:89], v[28:29], v[90:91] op_sel:[1,1,0] op_sel_hi:[0,1,1] neg_lo:[1,0,0]
  v_cvt_pk_f16_f32 v115, v100, -v101
  ds_write_addtid_b32 v115 offset:37120
  v_cvt_pk_f16_f32 v116, v90, -v91
  ds_write_addtid_b32 v116 offset:37392
  v_cvt_pk_f16_f32 v117, v108, -v109
  ds_write_addtid_b32 v117 offset:37664
  v_pk_mul_f32 v[96:97], v[100:101], v[28:29] op_sel_hi:[1,0]
  v_pk_mul_f32 v[104:105], v[108:109], v[28:29] op_sel_hi:[1,0]
  v_pk_mul_f32 v[88:89], v[90:91], v[28:29] op_sel_hi:[1,0]
  v_pk_fma_f32 v[96:97], v[100:101], v[28:29], v[96:97] op_sel:[1,1,0] op_sel_hi:[0,1,1] neg_lo:[1,0,0]
  v_pk_fma_f32 v[104:105], v[108:109], v[28:29], v[104:105] op_sel:[1,1,0] op_sel_hi:[0,1,1] neg_lo:[1,0,0]
  v_pk_fma_f32 v[88:89], v[90:91], v[28:29], v[88:89] op_sel:[1,1,0] op_sel_hi:[0,1,1] neg_lo:[1,0,0]
  v_cvt_pk_f16_f32 v114, v96, -v97
  ds_write_addtid_b32 v114 offset:38208
  v_cvt_pk_f16_f32 v115, v88, -v89
  ds_write_addtid_b32 v115 offset:38480
  v_cvt_pk_f16_f32 v116, v104, -v105
  ds_write_addtid_b32 v116 offset:38752
  v_pk_mul_f32 v[100:101], v[96:97], v[28:29] op_sel_hi:[1,0]
  v_pk_mul_f32 v[108:109], v[104:105], v[28:29] op_sel_hi:[1,0]
  v_pk_fma_f32 v[100:101], v[96:97], v[28:29], v[100:101] op_sel:[1,1,0] op_sel_hi:[0,1,1] neg_lo:[1,0,0]
  v_pk_fma_f32 v[108:109], v[104:105], v[28:29], v[108:109] op_sel:[1,1,0] op_sel_hi:[0,1,1] neg_lo:[1,0,0]
  v_cvt_pk_f16_f32 v117, v100, -v101
  ds_write_addtid_b32 v117 offset:37936
  v_cvt_pk_f16_f32 v114, v108, -v109
  ds_write_addtid_b32 v114 offset:39296
  s_load_dwordx8 s[16:23], s[46:47], s74 glc
  s_add_u32 s95, s74, 112
  s_load_dwordx8 s[24:31], s[46:47], s95 glc
  s_load_dwordx8 s[36:43], s[46:47], s75 glc
  s_mov_b32 m0, s73
  v_pk_mul_f32 v[96:97], v[100:101], v[28:29] op_sel_hi:[1,0]
  v_pk_mul_f32 v[104:105], v[108:109], v[28:29] op_sel_hi:[1,0]
  v_pk_fma_f32 v[96:97], v[100:101], v[28:29], v[96:97] op_sel:[1,1,0] op_sel_hi:[0,1,1] neg_lo:[1,0,0]
  v_pk_fma_f32 v[104:105], v[108:109], v[28:29], v[104:105] op_sel:[1,1,0] op_sel_hi:[0,1,1] neg_lo:[1,0,0]
  v_cvt_pk_f16_f32 v115, v96, -v97
  ds_write_addtid_b32 v115 offset:39024
  v_cvt_pk_f16_f32 v116, v104, -v105
  ds_write_addtid_b32 v116 offset:62144
  v_pk_mul_f32 v[100:101], v[96:97], v[28:29] op_sel_hi:[1,0]
  v_pk_mul_f32 v[108:109], v[104:105], v[28:29] op_sel_hi:[1,0]
  v_pk_fma_f32 v[100:101], v[96:97], v[28:29], v[100:101] op_sel:[1,1,0] op_sel_hi:[0,1,1] neg_lo:[1,0,0]
  v_pk_fma_f32 v[108:109], v[104:105], v[28:29], v[108:109] op_sel:[1,1,0] op_sel_hi:[0,1,1] neg_lo:[1,0,0]
  v_cvt_pk_f16_f32 v117, v100, -v101
  ds_write_addtid_b32 v117 offset:39568
  v_cvt_pk_f16_f32 v114, v108, -v109
  ds_write_addtid_b32 v114 offset:61600
  v_pk_mul_f32 v[96:97], v[100:101], v[28:29] op_sel_hi:[1,0]
  v_pk_mul_f32 v[104:105], v[108:109], v[28:29] op_sel_hi:[1,0]
  v_pk_fma_f32 v[96:97], v[100:101], v[28:29], v[96:97] op_sel:[1,1,0] op_sel_hi:[0,1,1] neg_lo:[1,0,0]
  v_pk_fma_f32 v[104:105], v[108:109], v[28:29], v[104:105] op_sel:[1,1,0] op_sel_hi:[0,1,1] neg_lo:[1,0,0]
  v_cvt_pk_f16_f32 v115, v96, -v97
  ds_write_addtid_b32 v115 offset:62416
  v_cvt_pk_f16_f32 v116, v104, -v105
  ds_write_addtid_b32 v116 offset:62688
  ds_read_b128 v[88:91], v36 offset:0
  ds_read_b128 v[92:95], v36 offset:32
  ds_read_b128 v[96:99], v36 offset:64
  ds_read_b128 v[100:103], v36 offset:96
  ds_read_b128 v[104:107], v36 offset:128
  ds_read_b128 v[108:111], v36 offset:160
  ds_read_b128 v[112:115], v36 offset:192
  ds_read_b128 v[116:119], v36 offset:224
  s_waitcnt lgkmcnt(0)
  v_mfma_f32_32x32x16_f16 v[120:135], v[88:91], v[56:59], 0
  v_mfma_f32_32x32x16_f16 v[120:135], v[92:95], v[60:63], v[120:135]
  v_mfma_f32_32x32x16_f16 v[120:135], v[96:99], v[64:67], v[120:135]
  v_mfma_f32_32x32x16_f16 v[120:135], v[100:103], v[68:71], v[120:135]
  v_mfma_f32_32x32x16_f16 v[120:135], v[104:107], v[72:75], v[120:135]
  v_mfma_f32_32x32x16_f16 v[120:135], v[108:111], v[76:79], v[120:135]
  v_mfma_f32_32x32x16_f16 v[120:135], v[112:115], v[80:83], v[120:135]
  v_mfma_f32_32x32x16_f16 v[120:135], v[116:119], v[84:87], v[120:135]
  s_waitcnt lgkmcnt(0)
  s_cmp_lg_u64 s[16:17], s[48:49]
  s_cselect_b32 s95, 1, 0
  s_cmp_lg_u64 s[18:19], s[48:49]
  s_addc_u32 s95, s95, 0
  s_cmp_lg_u64 s[20:21], s[48:49]
  s_addc_u32 s95, s95, 0
  s_cmp_lg_u64 s[22:23], s[48:49]
  s_addc_u32 s95, s95, 0
  s_cmp_lg_u64 s[24:25], s[48:49]
  s_addc_u32 s95, s95, 0
  s_cmp_lg_u64 s[26:27], s[48:49]
  s_addc_u32 s95, s95, 0
  s_cmp_lg_u64 s[28:29], s[48:49]
  s_addc_u32 s95, s95, 0
  s_cmp_lg_u64 s[30:31], s[48:49]
  s_addc_u32 s95, s95, 0
  s_cmp_lg_u64 s[36:37], s[48:49]
  s_addc_u32 s95, s95, 0
  s_cmp_lg_u64 s[38:39], s[48:49]
  s_addc_u32 s95, s95, 0
  s_cmp_lg_u64 s[40:41], s[48:49]
  s_addc_u32 s95, s95, 0
  s_cmp_lg_u64 s[42:43], s[48:49]
  s_addc_u32 s95, s95, 0
  s_cmp_eq_u32 s95, 0
  s_cbranch_scc0 SSLOW_21
SBACK_22:
  s_add_u32 m0, s79, 0
  s_nop 0
  buffer_load_dwordx4 v53, s[4:7], s78 offen sc1 lds
  s_add_u32 m0, s79, 28672
  s_nop 0
  buffer_load_dwordx4 v54, s[4:7], s78 offen sc1 lds
  s_add_u32 s78, s78, 2048
  s_add_u32 m0, s79, 1024
  s_nop 0
  buffer_load_dwordx4 v53, s[4:7], s78 offen sc1 lds
  s_add_u32 m0, s79, 29696
  s_nop 0
  buffer_load_dwordx4 v54, s[4:7], s78 offen sc1 lds
  s_add_u32 s78, s78, 2048
  s_add_u32 m0, s79, 2048
  s_nop 0
  buffer_load_dwordx4 v53, s[4:7], s78 offen sc1 lds
  s_add_u32 m0, s79, 30720
  s_nop 0
  buffer_load_dwordx4 v54, s[4:7], s78 offen sc1 lds
  s_add_u32 s78, s78, 2048
  s_add_u32 m0, s79, 3072
  s_nop 0
  buffer_load_dwordx4 v53, s[4:7], s78 offen sc1 lds
  s_add_u32 m0, s79, 31744
  s_nop 0
  buffer_load_dwordx4 v54, s[4:7], s78 offen sc1 lds
  s_add_u32 s78, s78, 2048
  s_add_u32 m0, s79, 4096
  s_nop 0
  buffer_load_dwordx4 v53, s[4:7], s78 offen sc1 lds
  s_add_u32 m0, s79, 32768
  s_nop 0
  buffer_load_dwordx4 v54, s[4:7], s78 offen sc1 lds
  s_add_u32 s78, s78, 2048
  s_add_u32 m0, s79, 5120
  s_nop 0
  buffer_load_dwordx4 v53, s[4:7], s78 offen sc1 lds
  s_add_u32 m0, s79, 33792
  s_nop 0
  buffer_load_dwordx4 v54, s[4:7], s78 offen sc1 lds
  s_add_u32 s78, s78, 2048
  s_add_u32 m0, s79, 6144
  s_nop 0
  buffer_load_dwordx4 v53, s[4:7], s78 offen sc1 lds
  s_add_u32 m0, s79, 34816
  s_nop 0
  buffer_load_dwordx4 v54, s[4:7], s78 offen sc1 lds
  s_mov_b32 m0, s60
  s_nop 0
  buffer_load_dwordx4 v52, s[8:11], s93 offen lds
  s_add_u32 s93, s93, 7168
  s_add_u32 m0, m0, 1024
  s_nop 0
  buffer_load_dwordx4 v52, s[8:11], s93 offen lds
  s_add_u32 s93, s93, 7168
  s_add_u32 m0, m0, 1024
  s_nop 0
  buffer_load_dwordx4 v52, s[8:11], s93 offen lds
  s_add_u32 s93, s93, 7168
  s_add_u32 m0, m0, 1024
  s_nop 0
  buffer_load_dwordx4 v52, s[8:11], s93 offen lds
  s_add_u32 s93, s93, 7168
  s_add_u32 m0, m0, 1024
  s_nop 0
  buffer_load_dwordx4 v52, s[8:11], s93 offen lds
  s_add_u32 s93, s93, 7168
  s_add_u32 m0, m0, 1024
  s_nop 0
  buffer_load_dwordx4 v52, s[8:11], s93 offen lds
  v_cvt_pk_f16_f32 v56, v120, v121
  v_cvt_pk_f16_f32 v57, v122, v123
  v_cvt_pk_f16_f32 v58, v124, v125
  v_cvt_pk_f16_f32 v59, v126, v127
  v_cvt_pk_f16_f32 v60, v128, v129
  v_cvt_pk_f16_f32 v61, v130, v131
  v_cvt_pk_f16_f32 v62, v132, v133
  v_cvt_pk_f16_f32 v63, v134, v135
  ds_write_b128 v37, v[56:59] offset:1024
  ds_write_b128 v37, v[60:63] offset:2048
  v_mov_b32 v11, 1
  s_mov_b64 exec, 1
  ds_add_u32 v10, v11
  s_mov_b64 exec, -1
  v_sub_f32 v84, 0, v40
  v_mov_b32 v86, v41
  v_dot2_f32_bf16 v56, v16, s69, v84
  v_dot2_f32_bf16 v57, v16, s70, v84
  v_dot2_f32_bf16 v58, v17, s69, v84
  v_dot2_f32_bf16 v59, v17, s70, v84
  v_dot2_f32_bf16 v60, v18, s69, v84
  v_dot2_f32_bf16 v61, v18, s70, v84
  v_dot2_f32_bf16 v62, v19, s69, v84
  v_dot2_f32_bf16 v63, v19, s70, v84
  v_dot2_f32_bf16 v64, v20, s69, v84
  v_dot2_f32_bf16 v65, v20, s70, v84
  v_dot2_f32_bf16 v66, v21, s69, v84
  v_dot2_f32_bf16 v67, v21, s70, v84
  v_dot2_f32_bf16 v68, v22, s69, v84
  v_dot2_f32_bf16 v69, v22, s70, v84
  v_dot2_f32_bf16 v70, v23, s69, v84
  v_dot2_f32_bf16 v71, v23, s70, v84
  v_pk_mul_f32 v[56:57], v[56:57], v[86:87] op_sel_hi:[1,0]
  v_pk_mul_f32 v[58:59], v[58:59], v[86:87] op_sel_hi:[1,0]
  v_pk_mul_f32 v[60:61], v[60:61], v[86:87] op_sel_hi:[1,0]
  v_pk_mul_f32 v[62:63], v[62:63], v[86:87] op_sel_hi:[1,0]
  v_pk_mul_f32 v[64:65], v[64:65], v[86:87] op_sel_hi:[1,0]
  v_pk_mul_f32 v[66:67], v[66:67], v[86:87] op_sel_hi:[1,0]
  v_pk_mul_f32 v[68:69], v[68:69], v[86:87] op_sel_hi:[1,0]
  v_pk_mul_f32 v[70:71], v[70:71], v[86:87] op_sel_hi:[1,0]
  v_cvt_pk_bf16_f32 v16, v56, v57
  v_cvt_pk_bf16_f32 v17, v58, v59
  v_cvt_pk_bf16_f32 v18, v60, v61
  v_cvt_pk_bf16_f32 v19, v62, v63
  v_cvt_pk_bf16_f32 v20, v64, v65
  v_cvt_pk_bf16_f32 v21, v66, v67
  v_cvt_pk_bf16_f32 v22, v68, v69
  v_cvt_pk_bf16_f32 v23, v70, v71
  s_load_dwordx8 s[16:23], s[46:47], s92 glc
  s_waitcnt lgkmcnt(0)
  s_cmp_lg_u64 s[16:17], s[48:49]
  s_cselect_b32 s95, 1, 0
  s_cmp_lg_u64 s[18:19], s[48:49]
  s_addc_u32 s95, s95, 0
  s_cmp_lg_u64 s[20:21], s[48:49]
  s_addc_u32 s95, s95, 0
  s_cmp_lg_u64 s[22:23], s[48:49]
  s_addc_u32 s95, s95, 0
  s_cmp_eq_u32 s95, 0
  s_cbranch_scc0 SSLOW_23
SBACK_24:
  s_setprio 0
  buffer_load_dwordx4 a[0:3], v12, s[4:7], s76 offen offset:0 sc1
  buffer_load_dwordx4 a[4:7], v12, s[4:7], s76 offen offset:2048 sc1
  v_add_u32 v12, 4096, v12
  buffer_load_dwordx4 a[8:11], v12, s[4:7], s76 offen offset:0 sc1
  buffer_load_dwordx4 a[12:15], v12, s[4:7], s76 offen offset:2048 sc1
  v_add_u32 v12, 4096, v12
  s_waitcnt vmcnt(10)
  s_waitcnt vmcnt(4)
  s_setprio 2
  s_waitcnt lgkmcnt(0)
  v_mov_b32 v10, 163328
  v_mov_b32 v11, 1
  s_mov_b64 exec, 1
  ds_add_rtn_u32 v11, v10, v11 offset:12
  s_mov_b64 exec, -1
  s_waitcnt lgkmcnt(0)
  v_readfirstlane_b32 s55, v11
  s_nop 0
  s_cmp_ge_u32 s55, 3
  s_cbranch_scc1 LBD_26
  s_mov_b32 s96, 400000
LB_25:
  ds_read_b32 v11, v10 offset:12
  s_waitcnt lgkmcnt(0)
  v_readfirstlane_b32 s55, v11
  s_nop 0
  s_cmp_ge_u32 s55, 4
  s_cbranch_scc1 LBD_26
  s_sub_u32 s96, s96, 1
  s_cmp_lg_u32 s96, 0
  s_cbranch_scc1 LB_25
  s_or_b32 s97, s97, 512
LBD_26:
  ds_read_b128 v[104:107], v35 offset:0
  ds_read_b64_tr_b16 v[108:109], v34 offset:0
  ds_read_b64_tr_b16 v[110:111], v34 offset:512
  ds_read_b128 v[112:115], v35 offset:7168
  ds_read_b64_tr_b16 v[116:117], v34 offset:14336
  ds_read_b64_tr_b16 v[118:119], v34 offset:14848
  ds_read_b128 v[120:123], v35 offset:14336
  ds_read_b64_tr_b16 v[124:125], v34 offset:28672
  ds_read_b64_tr_b16 v[126:127], v34 offset:29184
  s_waitcnt lgkmcnt(6)
  v_mfma_f32_32x32x16_bf16 v[56:71], v[108:111], v[104:107], 0
  ds_read_b128 v[128:131], v35 offset:21504
  ds_read_b64_tr_b16 v[132:133], v34 offset:43008
  ds_read_b64_tr_b16 v[134:135], v34 offset:43520
  buffer_load_dwordx4 a[16:19], v12, s[4:7], s76 offen offset:0 sc1
  s_waitcnt lgkmcnt(6)
  v_mfma_f32_32x32x16_bf16 v[56:71], v[116:119], v[112:115], v[56:71]
  ds_read_b128 v[104:107], v35 offset:1024
  ds_read_b64_tr_b16 v[108:109], v34 offset:2048
  ds_read_b64_tr_b16 v[110:111], v34 offset:2560
  s_waitcnt lgkmcnt(6)
  v_mfma_f32_32x32x16_bf16 v[56:71], v[124:127], v[120:123], v[56:71]
  ds_read_b128 v[112:115], v35 offset:8192
  ds_read_b64_tr_b16 v[116:117], v34 offset:16384
  ds_read_b64_tr_b16 v[118:119], v34 offset:16896
  s_waitcnt lgkmcnt(6)
  v_mfma_f32_32x32x16_bf16 v[56:71], v[132:135], v[128:131], v[56:71]
  ds_read_b128 v[120:123], v35 offset:15360
  ds_read_b64_tr_b16 v[124:125], v34 offset:30720
  ds_read_b64_tr_b16 v[126:127], v34 offset:31232
  s_waitcnt lgkmcnt(6)
  v_mfma_f32_32x32x16_bf16 v[56:71], v[108:111], v[104:107], v[56:71]
  ds_read_b128 v[128:131], v35 offset:22528
  ds_read_b64_tr_b16 v[132:133], v34 offset:45056
  ds_read_b64_tr_b16 v[134:135], v34 offset:45568
  buffer_load_dwordx4 a[20:23], v12, s[4:7], s76 offen offset:2048 sc1
  v_add_u32 v12, 4096, v12
  s_waitcnt lgkmcnt(6)
  v_mfma_f32_32x32x16_bf16 v[56:71], v[116:119], v[112:115], v[56:71]
  ds_read_b128 v[104:107], v35 offset:2048
  ds_read_b64_tr_b16 v[108:109], v34 offset:4096
  ds_read_b64_tr_b16 v[110:111], v34 offset:4608
  s_waitcnt lgkmcnt(6)
  v_mfma_f32_32x32x16_bf16 v[56:71], v[124:127], v[120:123], v[56:71]
  ds_read_b128 v[112:115], v35 offset:9216
  ds_read_b64_tr_b16 v[116:117], v34 offset:18432
  ds_read_b64_tr_b16 v[118:119], v34 offset:18944
  s_waitcnt lgkmcnt(6)
  v_mfma_f32_32x32x16_bf16 v[56:71], v[132:135], v[128:131], v[56:71]
  ds_read_b128 v[120:123], v35 offset:16384
  ds_read_b64_tr_b16 v[124:125], v34 offset:32768
  ds_read_b64_tr_b16 v[126:127], v34 offset:33280
  s_waitcnt lgkmcnt(6)
  v_mfma_f32_32x32x16_bf16 v[56:71], v[108:111], v[104:107], v[56:71]
  ds_read_b128 v[128:131], v35 offset:23552
  ds_read_b64_tr_b16 v[132:133], v34 offset:47104
  ds_read_b64_tr_b16 v[134:135], v34 offset:47616
  s_waitcnt lgkmcnt(6)
  v_mfma_f32_32x32x16_bf16 v[56:71], v[116:119], v[112:115], v[56:71]
  ds_read_b128 v[104:107], v35 offset:3072
  ds_read_b64_tr_b16 v[108:109], v34 offset:6144
  ds_read_b64_tr_b16 v[110:111], v34 offset:6656
  s_waitcnt lgkmcnt(6)
  v_mfma_f32_32x32x16_bf16 v[56:71], v[124:127], v[120:123], v[56:71]
  ds_read_b128 v[112:115], v35 offset:10240
  ds_read_b64_tr_b16 v[116:117], v34 offset:20480
  ds_read_b64_tr_b16 v[118:119], v34 offset:20992
  buffer_load_dwordx4 a[24:27], v12, s[4:7], s76 offen offset:0 sc1
  s_waitcnt lgkmcnt(6)
  v_mfma_f32_32x32x16_bf16 v[56:71], v[132:135], v[128:131], v[56:71]
  ds_read_b128 v[120:123], v35 offset:17408
  ds_read_b64_tr_b16 v[124:125], v34 offset:34816
  ds_read_b64_tr_b16 v[126:127], v34 offset:35328
  s_waitcnt lgkmcnt(6)
  v_mfma_f32_32x32x16_bf16 v[56:71], v[108:111], v[104:107], v[56:71]
  ds_read_b128 v[128:131], v35 offset:24576
  ds_read_b64_tr_b16 v[132:133], v34 offset:49152
  ds_read_b64_tr_b16 v[134:135], v34 offset:49664
  s_waitcnt lgkmcnt(6)
  v_mfma_f32_32x32x16_bf16 v[56:71], v[116:119], v[112:115], v[56:71]
  ds_read_b128 v[104:107], v35 offset:4096
  ds_read_b64_tr_b16 v[108:109], v34 offset:8192
  ds_read_b64_tr_b16 v[110:111], v34 offset:8704
  s_waitcnt lgkmcnt(6)
  v_mfma_f32_32x32x16_bf16 v[56:71], v[124:127], v[120:123], v[56:71]
  ds_read_b128 v[112:115], v35 offset:11264
  ds_read_b64_tr_b16 v[116:117], v34 offset:22528
  ds_read_b64_tr_b16 v[118:119], v34 offset:23040
  s_waitcnt lgkmcnt(6)
  v_mfma_f32_32x32x16_bf16 v[56:71], v[132:135], v[128:131], v[56:71]
  ds_read_b128 v[120:123], v35 offset:18432
  ds_read_b64_tr_b16 v[124:125], v34 offset:36864
  ds_read_b64_tr_b16 v[126:127], v34 offset:37376
  s_waitcnt lgkmcnt(6)
  v_mfma_f32_32x32x16_bf16 v[56:71], v[108:111], v[104:107], v[56:71]
  ds_read_b128 v[128:131], v35 offset:25600
  ds_read_b64_tr_b16 v[132:133], v34 offset:51200
  ds_read_b64_tr_b16 v[134:135], v34 offset:51712
  buffer_load_dwordx4 a[28:31], v12, s[4:7], s76 offen offset:2048 sc1
  v_add_u32 v12, 4096, v12
  s_waitcnt lgkmcnt(6)
  v_mfma_f32_32x32x16_bf16 v[56:71], v[116:119], v[112:115], v[56:71]
  ds_read_b128 v[104:107], v35 offset:5120
  ds_read_b64_tr_b16 v[108:109], v34 offset:10240
  ds_read_b64_tr_b16 v[110:111], v34 offset:10752
  s_waitcnt lgkmcnt(6)
  v_mfma_f32_32x32x16_bf16 v[56:71], v[124:127], v[120:123], v[56:71]
  ds_read_b128 v[112:115], v35 offset:12288
  ds_read_b64_tr_b16 v[116:117], v34 offset:24576
  ds_read_b64_tr_b16 v[118:119], v34 offset:25088
  s_waitcnt lgkmcnt(6)
  v_mfma_f32_32x32x16_bf16 v[56:71], v[132:135], v[128:131], v[56:71]
  ds_read_b128 v[120:123], v35 offset:19456
  ds_read_b64_tr_b16 v[124:125], v34 offset:38912
  ds_read_b64_tr_b16 v[126:127], v34 offset:39424
  s_waitcnt lgkmcnt(6)
  v_mfma_f32_32x32x16_bf16 v[56:71], v[108:111], v[104:107], v[56:71]
  ds_read_b128 v[128:131], v35 offset:26624
  ds_read_b64_tr_b16 v[132:133], v34 offset:53248
  ds_read_b64_tr_b16 v[134:135], v34 offset:53760
  s_waitcnt lgkmcnt(6)
  v_mfma_f32_32x32x16_bf16 v[56:71], v[116:119], v[112:115], v[56:71]
  ds_read_b128 v[104:107], v35 offset:6144
  ds_read_b64_tr_b16 v[108:109], v34 offset:12288
  ds_read_b64_tr_b16 v[110:111], v34 offset:12800
  s_waitcnt lgkmcnt(6)
  v_mfma_f32_32x32x16_bf16 v[56:71], v[124:127], v[120:123], v[56:71]
  ds_read_b128 v[112:115], v35 offset:13312
  ds_read_b64_tr_b16 v[116:117], v34 offset:26624
  ds_read_b64_tr_b16 v[118:119], v34 offset:27136
  buffer_load_dwordx4 a[32:35], v12, s[4:7], s76 offen offset:0 sc1
  s_waitcnt lgkmcnt(6)
  v_mfma_f32_32x32x16_bf16 v[56:71], v[132:135], v[128:131], v[56:71]
  ds_read_b128 v[120:123], v35 offset:20480
  ds_read_b64_tr_b16 v[124:125], v34 offset:40960
  ds_read_b64_tr_b16 v[126:127], v34 offset:41472
  s_waitcnt lgkmcnt(6)
  v_mfma_f32_32x32x16_bf16 v[56:71], v[108:111], v[104:107], v[56:71]
  ds_read_b128 v[128:131], v35 offset:27648
  ds_read_b64_tr_b16 v[132:133], v34 offset:55296
  ds_read_b64_tr_b16 v[134:135], v34 offset:55808
  s_waitcnt lgkmcnt(6)
  v_mfma_f32_32x32x16_bf16 v[56:71], v[116:119], v[112:115], v[56:71]
  s_waitcnt lgkmcnt(3)
  v_mfma_f32_32x32x16_bf16 v[56:71], v[124:127], v[120:123], v[56:71]
  s_waitcnt lgkmcnt(0)
  v_mfma_f32_32x32x16_bf16 v[56:71], v[132:135], v[128:131], v[56:71]
  v_mov_b32 v11, 1
  v_mov_b32 v10, 163328
  s_mov_b64 exec, 1
  ds_add_u32 v10, v11 offset:20
  s_mov_b64 exec, -1
  s_add_u32 s33, s71, 6291456
  s_lshl_b32 s57, s50, 13
  s_lshl_b32 s55, s51, 10
  s_add_u32 s57, s57, s55
  s_lshl_b32 s55, s54, 9
  s_add_u32 s57, s57, s55
  s_lshl_b32 s55, s53, 7
  s_add_u32 s57, s57, s55
  s_add_u32 s57, s57, 8388608
  v_lshlrev_b32 v55, 8, v15
  v_lshl_add_u32 v55, v14, 2, v55
  v_mov_b32 v72, 0
  v_mov_b32 v73, 0
  v_mov_b32 v74, 0
  v_mov_b32 v75, 0
  v_dot2_f32_bf16 v56, v16, s69, v56
  v_dot2_f32_bf16 v57, v16, s70, v57
  v_dot2_f32_bf16 v58, v17, s69, v58
  v_dot2_f32_bf16 v59, v17, s70, v59
  v_dot2_f32_bf16 v60, v18, s69, v60
  v_dot2_f32_bf16 v61, v18, s70, v61
  v_dot2_f32_bf16 v62, v19, s69, v62
  v_dot2_f32_bf16 v63, v19, s70, v63
  v_dot2_f32_bf16 v64, v20, s69, v64
  v_dot2_f32_bf16 v65, v20, s70, v65
  v_dot2_f32_bf16 v66, v21, s69, v66
  v_dot2_f32_bf16 v67, v21, s70, v67
  v_dot2_f32_bf16 v68, v22, s69, v68
  v_dot2_f32_bf16 v69, v22, s70, v69
  v_dot2_f32_bf16 v70, v23, s69, v70
  v_dot2_f32_bf16 v71, v23, s70, v71
  v_cvt_pk_bf16_f32 v16, v56, v57
  v_cvt_pk_bf16_f32 v17, v58, v59
  v_cvt_pk_bf16_f32 v18, v60, v61
  v_cvt_pk_bf16_f32 v19, v62, v63
  v_cvt_pk_bf16_f32 v20, v64, v65
  v_cvt_pk_bf16_f32 v21, v66, v67
  v_cvt_pk_bf16_f32 v22, v68, v69
  v_cvt_pk_bf16_f32 v23, v70, v71
  buffer_store_dwordx4 v[16:19], v1, s[4:7], s33 offen sc1
  buffer_store_dwordx4 v[20:23], v1, s[4:7], s33 offen offset:2048 sc1
  v_dot2_f32_bf16 v72, v16, s68, v72
  v_dot2_f32_bf16 v74, v16, v16, v74
  v_dot2_f32_bf16 v73, v17, s68, v73
  v_dot2_f32_bf16 v75, v17, v17, v75
  v_dot2_f32_bf16 v72, v18, s68, v72
  v_dot2_f32_bf16 v74, v18, v18, v74
  v_dot2_f32_bf16 v73, v19, s68, v73
  v_dot2_f32_bf16 v75, v19, v19, v75
  v_dot2_f32_bf16 v72, v20, s68, v72
  v_dot2_f32_bf16 v74, v20, v20, v74
  v_dot2_f32_bf16 v73, v21, s68, v73
  v_dot2_f32_bf16 v75, v21, v21, v75
  v_dot2_f32_bf16 v72, v22, s68, v72
  v_dot2_f32_bf16 v74, v22, v22, v74
  v_dot2_f32_bf16 v73, v23, s68, v73
  v_dot2_f32_bf16 v75, v23, v23, v75
  s_nop 1
  v_add_f32 v72, v72, v73
  v_add_f32 v74, v74, v75
  s_nop 1
  v_permlane32_swap_b32 v72, v74
  v_add_f32 v72, v72, v74
  buffer_store_dword v72, v55, s[4:7], s57 offen sc1
  s_setprio 0
  buffer_load_dwordx4 a[36:39], v12, s[4:7], s76 offen offset:2048 sc1
  v_add_u32 v12, 4096, v12
  buffer_load_dwordx4 a[40:43], v12, s[4:7], s76 offen offset:0 sc1
  buffer_load_dwordx4 a[44:47], v12, s[4:7], s76 offen offset:2048 sc1
  v_add_u32 v12, 4096, v12
  buffer_load_dwordx4 a[48:51], v12, s[4:7], s76 offen offset:0 sc1
  s_setprio 2
  s_lshl_b32 s56, s52, 6
  s_lshl_b32 s75, s51, 3
  s_add_u32 s75, s75, s90
  s_add_u32 s75, s75, s56
  s_add_u32 s74, s92, s56
  s_add_u32 s74, s74, 896
  s_lshl_b32 s55, s54, 12
  s_lshl_b32 s56, s53, 9
  s_add_u32 s78, s55, s56
  s_add_u32 s78, s78, s66
  s_add_u32 s78, s78, 6291456
  s_mul_i32 s79, s53, 28672
  s_lshl_b32 s55, s54, 11
  s_add_u32 s79, s79, s55
  s_add_u32 s79, s79, 47104
  v_mov_b32 v53, v1
  s_lshl_b32 s73, s50, 13
  s_lshl_b32 s55, s54, 9
  s_add_u32 s73, s73, s55
  s_lshl_b32 s55, s53, 7
  s_add_u32 s73, s73, s55
  s_add_u32 s73, s73, 8388608
  s_lshl_b32 s72, s52, 11
  s_add_u32 s72, s72, 104448
  v_lshrrev_b32 v54, 4, v0
  v_lshlrev_b32 v54, 10, v54
  v_bfe_u32 v55, v0, 3, 1
  v_lshl_add_u32 v54, v55, 8, v54
  v_and_b32 v55, 7, v0
  v_lshl_add_u32 v54, v55, 4, v54
  s_waitcnt vmcnt(4)
  s_lshl_b32 s55, s52, 6
  v_add_u32 v4, s55, v5
  s_mov_b64 exec, 0x7f
  buffer_store_dwordx2 v[8:9], v4, s[4:7], 0 offen offset:896 sc1
  s_mov_b64 exec, -1
  s_setprio 0
  buffer_load_dwordx4 a[52:55], v12, s[4:7], s76 offen offset:2048 sc1
  v_add_u32 v12, 4096, v12
  buffer_load_dwordx4 a[56:59], v12, s[4:7], s76 offen offset:0 sc1
  buffer_load_dwordx4 a[60:63], v12, s[4:7], s76 offen offset:2048 sc1
  v_add_u32 v12, 4096, v12
  buffer_load_dwordx4 a[64:67], v12, s[4:7], s76 offen offset:0 sc1
  buffer_load_dwordx4 a[68:71], v12, s[4:7], s76 offen offset:2048 sc1
  v_add_u32 v12, 4096, v12
  buffer_load_dwordx4 a[72:75], v12, s[4:7], s76 offen offset:0 sc1
  buffer_load_dwordx4 a[76:79], v12, s[4:7], s76 offen offset:2048 sc1
  v_add_u32 v12, 4096, v12
  buffer_load_dwordx4 a[80:83], v12, s[4:7], s76 offen offset:0 sc1
  s_load_dwordx16 s[16:31], s[46:47], s74 glc
  ds_read_b32 v11, v10 offset:20
  buffer_load_dwordx4 a[84:87], v12, s[4:7], s76 offen offset:2048 sc1
  v_add_u32 v12, 4096, v12
  buffer_load_dwordx4 a[88:91], v12, s[4:7], s76 offen offset:0 sc1
  buffer_load_dwordx4 a[92:95], v12, s[4:7], s76 offen offset:2048 sc1
  v_add_u32 v12, 4096, v12
  buffer_load_dwordx4 a[96:99], v12, s[4:7], s76 offen offset:0 sc1
  s_waitcnt lgkmcnt(0)
  v_readfirstlane_b32 s55, v11
  s_nop 0
  s_cmp_ge_u32 s55, 4
  s_cbranch_scc1 LBD_28
  s_mov_b32 s96, 400000
LB_27:
  ds_read_b32 v11, v10 offset:20
  s_waitcnt lgkmcnt(0)
  v_readfirstlane_b32 s55, v11
  s_nop 0
  s_cmp_ge_u32 s55, 4
  s_cbranch_scc1 LBD_28
  s_sub_u32 s96, s96, 1
  s_cmp_lg_u32 s96, 0
  s_cbranch_scc1 LB_27
  s_or_b32 s97, s97, 512
LBD_28:
  s_waitcnt lgkmcnt(0)
  s_cmp_lg_u64 s[16:17], s[48:49]
  s_cselect_b32 s95, 1, 0
  s_cmp_lg_u64 s[18:19], s[48:49]
  s_addc_u32 s95, s95, 0
  s_cmp_lg_u64 s[20:21], s[48:49]
  s_addc_u32 s95, s95, 0
  s_cmp_lg_u64 s[22:23], s[48:49]
  s_addc_u32 s95, s95, 0
  s_cmp_lg_u64 s[24:25], s[48:49]
  s_addc_u32 s95, s95, 0
  s_cmp_lg_u64 s[26:27], s[48:49]
  s_addc_u32 s95, s95, 0
  s_cmp_lg_u64 s[28:29], s[48:49]
  s_addc_u32 s95, s95, 0
  s_cmp_eq_u32 s95, 0
  s_cbranch_scc0 SSLOW_29
SBACK_30:
  s_setprio 2
  s_mov_b32 m0, s72
  s_nop 0
  buffer_load_dwordx4 v54, s[4:7], s73 offen sc1 lds
  s_add_u32 s73, s73, 3072
  buffer_load_dwordx4 v54, s[4:7], s73 offen offset:1024 sc1 lds
  s_add_u32 m0, s79, 0
  s_nop 0
  buffer_load_dwordx4 v53, s[4:7], s78 offen sc1 lds
  v_add_u32 v53, 2048, v53
  s_add_u32 m0, s79, 1024
  s_nop 0
  buffer_load_dwordx4 v53, s[4:7], s78 offen sc1 lds
  v_add_u32 v53, 6144, v53
  s_add_u32 m0, s79, 4096
  s_nop 0
  buffer_load_dwordx4 v53, s[4:7], s78 offen sc1 lds
  v_add_u32 v53, 2048, v53
  s_add_u32 m0, s79, 5120
  s_nop 0
  buffer_load_dwordx4 v53, s[4:7], s78 offen sc1 lds
  v_add_u32 v53, 6144, v53
  s_add_u32 m0, s79, 8192
  s_nop 0
  buffer_load_dwordx4 v53, s[4:7], s78 offen sc1 lds
  v_add_u32 v53, 2048, v53
  s_add_u32 m0, s79, 9216
  s_nop 0
  buffer_load_dwordx4 v53, s[4:7], s78 offen sc1 lds
  v_add_u32 v53, 6144, v53
  s_add_u32 m0, s79, 12288
  s_nop 0
  buffer_load_dwordx4 v53, s[4:7], s78 offen sc1 lds
  v_add_u32 v53, 2048, v53
  s_add_u32 m0, s79, 13312
  s_nop 0
  buffer_load_dwordx4 v53, s[4:7], s78 offen sc1 lds
  v_add_u32 v53, 6144, v53
  s_add_u32 m0, s79, 16384
  s_nop 0
  buffer_load_dwordx4 v53, s[4:7], s78 offen sc1 lds
  v_add_u32 v53, 2048, v53
  s_add_u32 m0, s79, 17408
  s_nop 0
  buffer_load_dwordx4 v53, s[4:7], s78 offen sc1 lds
  v_add_u32 v53, 6144, v53
  s_add_u32 m0, s79, 20480
  s_nop 0
  buffer_load_dwordx4 v53, s[4:7], s78 offen sc1 lds
  v_add_u32 v53, 2048, v53
  s_add_u32 m0, s79, 21504
  s_nop 0
  buffer_load_dwordx4 v53, s[4:7], s78 offen sc1 lds
  v_add_u32 v53, 6144, v53
  s_add_u32 m0, s79, 24576
  s_nop 0
  buffer_load_dwordx4 v53, s[4:7], s78 offen sc1 lds
  v_add_u32 v53, 2048, v53
  s_add_u32 m0, s79, 25600
  s_nop 0
  buffer_load_dwordx4 v53, s[4:7], s78 offen sc1 lds
  buffer_load_dwordx4 a[100:103], v12, s[4:7], s76 offen offset:2048 sc1
  v_add_u32 v12, 4096, v12
  buffer_load_dwordx4 a[104:107], v12, s[4:7], s76 offen offset:0 sc1
  buffer_load_dwordx4 a[108:111], v12, s[4:7], s76 offen offset:2048 sc1
  v_add_u32 v12, 4096, v12
  s_add_u32 s95, s92, 32
  s_load_dwordx8 s[16:23], s[46:47], s95 glc
  s_waitcnt lgkmcnt(0)
  s_cmp_lg_u64 s[16:17], s[48:49]
  s_cselect_b32 s95, 1, 0
  s_cmp_lg_u64 s[18:19], s[48:49]
  s_addc_u32 s95, s95, 0
  s_cmp_lg_u64 s[20:21], s[48:49]
  s_addc_u32 s95, s95, 0
  s_cmp_lg_u64 s[22:23], s[48:49]
  s_addc_u32 s95, s95, 0
  s_cmp_eq_u32 s95, 0
  s_cbranch_scc0 SSLOW_31
SBACK_32:
  buffer_load_dwordx4 a[112:115], v12, s[4:7], s76 offen offset:0 sc1
  v_mov_b32 v12, v2
  s_add_u32 s95, s77, s12
  buffer_load_dwordx4 v[80:83], v2, s[4:7], s95 offen offset:0 sc1
  s_add_u32 s95, s77, s12
  buffer_load_dwordx4 v[84:87], v2, s[4:7], s95 offen offset:1024 sc1
  s_add_u32 s95, s77, s12
  buffer_load_dwordx4 v[88:91], v2, s[4:7], s95 offen offset:2048 sc1
  s_add_u32 s95, s77, s12
  buffer_load_dwordx4 v[92:95], v2, s[4:7], s95 offen offset:3072 sc1
  s_add_u32 s95, s77, s13
  buffer_load_dwordx4 v[96:99], v2, s[4:7], s95 offen offset:0 sc1
  s_add_u32 s95, s77, s13
  buffer_load_dwordx4 v[100:103], v2, s[4:7], s95 offen offset:1024 sc1
  s_add_u32 s95, s77, s13
  buffer_load_dwordx4 v[104:107], v2, s[4:7], s95 offen offset:2048 sc1
  s_add_u32 s95, s77, s13
  buffer_load_dwordx4 v[108:111], v2, s[4:7], s95 offen offset:3072 sc1
  s_add_u32 s95, s77, s14
  buffer_load_dwordx4 v[112:115], v2, s[4:7], s95 offen offset:0 sc1
  s_add_u32 s95, s77, s14
  buffer_load_dwordx4 v[116:119], v2, s[4:7], s95 offen offset:1024 sc1
  s_add_u32 s95, s77, s14
  buffer_load_dwordx4 v[120:123], v2, s[4:7], s95 offen offset:2048 sc1
  s_add_u32 s95, s77, s14
  buffer_load_dwordx4 v[124:127], v2, s[4:7], s95 offen offset:3072 sc1
  s_add_u32 s95, s77, s15
  buffer_load_dwordx4 v[128:131], v2, s[4:7], s95 offen offset:0 sc1
  s_add_u32 s95, s77, s15
  buffer_load_dwordx4 v[132:135], v2, s[4:7], s95 offen offset:1024 sc1
  s_waitcnt vmcnt(18)
  s_waitcnt lgkmcnt(0)
JOIN:
  s_barrier
  v_mov_b32 v7, v3
  s_lshl_b32 s55, s91, 6
  v_add_u32 v5, s55, v5
  s_lshl_b32 s63, s51, 3
  s_add_u32 s63, s63, s90
  s_add_u32 s63, s63, s55
  s_add_u32 s62, s92, s55
  s_add_u32 s62, s62, 2048
  v_add_u32 v3, 47104, v2
  v_and_b32 v4, 31, v0
  v_lshlrev_b32 v4, 4, v4
  v_add_u32 v4, 161792, v4
  s_lshr_b32 s55, s91, 2
  s_cmp_eq_u32 s55, 0
  s_setprio 2
  s_cbranch_scc0 PR_33
  s_setprio 3
PR_33:
  s_cmp_ge_u32 s91, 4
  s_cbranch_scc1 YPATH
  ds_read_b128 v[48:51], v3 offset:0
  ds_read_b128 v[52:55], v3 offset:1024
  ds_read_b128 v[56:59], v3 offset:2048
  s_waitcnt lgkmcnt(1)
  v_mfma_f32_32x32x16_bf16 v[16:31], a[0:3], v[48:51], 0
  ds_read_b128 v[60:63], v3 offset:3072
  v_lshlrev_b32 v79, 12, v15
  v_lshl_add_u32 v79, v14, 2, v79
  v_add_u32 v79, 104448, v79
  v_mfma_f32_32x32x16_bf16 v[16:31], a[4:7], v[52:55], v[16:31]
  ds_read_b128 v[48:51], v3 offset:4096
  v_add_u32 v78, 1024, v79
  v_add_u32 v77, 2048, v79
  v_add_u32 v76, 3072, v79
  ds_read2_b32 v[32:33], v79 offset0:0 offset1:32
  s_waitcnt lgkmcnt(2)
  v_mfma_f32_32x32x16_bf16 v[16:31], a[8:11], v[56:59], v[16:31]
  ds_read_b128 v[52:55], v3 offset:5120
  ds_read2_b32 v[34:35], v79 offset0:64 offset1:96
  ds_read2_b32 v[36:37], v79 offset0:128 offset1:160
  ds_read2_b32 v[38:39], v79 offset0:192 offset1:224
  v_mfma_f32_32x32x16_bf16 v[16:31], a[12:15], v[60:63], v[16:31]
  ds_read_b128 v[56:59], v3 offset:6144
  ds_read2_b32 v[40:41], v78 offset0:0 offset1:32
  ds_read2_b32 v[42:43], v78 offset0:64 offset1:96
  ds_read2_b32 v[44:45], v78 offset0:128 offset1:160
  s_waitcnt lgkmcnt(7)
  v_mfma_f32_32x32x16_bf16 v[16:31], a[16:19], v[48:51], v[16:31]
  ds_read_b128 v[60:63], v3 offset:7168
  ds_read2_b32 v[46:47], v77 offset0:0 offset1:32
  ds_read2_b32 v[64:65], v77 offset0:64 offset1:96
  ds_read2_b32 v[66:67], v77 offset0:128 offset1:160
  ds_read2_b32 v[68:69], v77 offset0:192 offset1:224
  v_mfma_f32_32x32x16_bf16 v[16:31], a[20:23], v[52:55], v[16:31]
  ds_read_b128 v[48:51], v3 offset:8192
  ds_read2_b32 v[70:71], v76 offset0:0 offset1:32
  ds_read2_b32 v[72:73], v76 offset0:64 offset1:96
  ds_read2_b32 v[74:75], v76 offset0:128 offset1:160
  s_waitcnt lgkmcnt(8)
  v_mfma_f32_32x32x16_bf16 v[16:31], a[24:27], v[56:59], v[16:31]
  ds_read_b128 v[52:55], v3 offset:9216
  s_waitcnt lgkmcnt(1)
  v_add_u32 v79, 161792, v2
  v_add_f32 v32, v32, v46
  v_mfma_f32_32x32x16_bf16 v[16:31], a[28:31], v[60:63], v[16:31]
  ds_read_b128 v[56:59], v3 offset:10240
  v_add_f32 v33, v33, v47
  v_add_f32 v34, v34, v64
  v_add_f32 v35, v35, v65
  v_add_f32 v36, v36, v66
  s_waitcnt lgkmcnt(1)
  v_mfma_f32_32x32x16_bf16 v[16:31], a[32:35], v[48:51], v[16:31]
  ds_read_b128 v[60:63], v3 offset:11264
  v_add_f32 v37, v37, v67
  v_add_f32 v38, v38, v68
  v_add_f32 v39, v39, v69
  v_mfma_f32_32x32x16_bf16 v[16:31], a[36:39], v[52:55], v[16:31]
  ds_read_b128 v[48:51], v3 offset:12288
  v_add_f32 v40, v40, v70
  v_add_f32 v41, v41, v71
  v_add_f32 v42, v42, v72
  s_waitcnt lgkmcnt(1)
  v_mfma_f32_32x32x16_bf16 v[16:31], a[40:43], v[56:59], v[16:31]
  ds_read_b128 v[52:55], v3 offset:13312
  v_add_f32 v43, v43, v73
  v_add_f32 v44, v44, v74
  v_add_f32 v45, v45, v75
  v_add_f32 v32, v32, v34
  v_mfma_f32_32x32x16_bf16 v[16:31], a[44:47], v[60:63], v[16:31]
  ds_read_b128 v[56:59], v3 offset:14336
  v_add_f32 v33, v33, v35
  v_add_f32 v36, v36, v38
  v_add_f32 v37, v37, v39
  s_waitcnt lgkmcnt(1)
  v_mfma_f32_32x32x16_bf16 v[16:31], a[48:51], v[48:51], v[16:31]
  ds_read_b128 v[60:63], v3 offset:15360
  v_add_f32 v40, v40, v42
  v_add_f32 v41, v41, v43
  v_add_f32 v32, v32, v36
  v_mfma_f32_32x32x16_bf16 v[16:31], a[52:55], v[52:55], v[16:31]
  ds_read_b128 v[48:51], v3 offset:16384
  v_add_f32 v33, v33, v37
  v_add_f32 v40, v40, v44
  v_add_f32 v41, v41, v45
  v_add_f32 v32, v32, v40
  s_waitcnt lgkmcnt(1)
  v_mfma_f32_32x32x16_bf16 v[16:31], a[56:59], v[56:59], v[16:31]
  ds_read_b128 v[52:55], v3 offset:17408
  v_add_f32 v33, v33, v41
  v_mul_f32 v32, 0x3b124925, v32
  v_mul_f32 v33, 0x3b124925, v33
  v_mfma_f32_32x32x16_bf16 v[16:31], a[60:63], v[60:63], v[16:31]
  ds_read_b128 v[56:59], v3 offset:18432
  v_fma_f32 v33, -v32, v32, v33
  v_max_f32 v33, 0, v33
  v_cvt_pk_bf16_f32 v39, -v32, -v32
  s_waitcnt lgkmcnt(1)
  v_mfma_f32_32x32x16_bf16 v[16:31], a[64:67], v[48:51], v[16:31]
  ds_read_b128 v[60:63], v3 offset:19456
  v_cvt_pk_bf16_f32 v36, v33, v33
  v_and_b32 v36, 0xffff0000, v36
  v_add_f32 v36, 0x3727c5ac, v36
  v_cvt_pk_bf16_f32 v36, v36, v36
  v_mfma_f32_32x32x16_bf16 v[16:31], a[68:71], v[52:55], v[16:31]
  ds_read_b128 v[48:51], v3 offset:20480
  v_and_b32 v36, 0xffff0000, v36
  v_sqrt_f32 v36, v36
  s_nop 0
  v_cvt_pk_bf16_f32 v36, v36, v36
  s_waitcnt lgkmcnt(1)
  v_mfma_f32_32x32x16_bf16 v[16:31], a[72:75], v[56:59], v[16:31]
  ds_read_b128 v[52:55], v3 offset:21504
  v_and_b32 v36, 0xffff0000, v36
  v_rcp_f32 v38, v36
  s_nop 0
  v_mul_f32 v37, 0xc0135761, v38
  v_mfma_f32_32x32x16_bf16 v[16:31], a[76:79], v[60:63], v[16:31]
  ds_read_b128 v[56:59], v3 offset:22528
  v_mul_f32 v38, v38, v38
  v_mul_f32 v38, 0x3d372713, v38
  v_mul_f32 v38, v38, v37
  s_waitcnt lgkmcnt(1)
  v_mfma_f32_32x32x16_bf16 v[16:31], a[80:83], v[48:51], v[16:31]
  ds_read_b128 v[60:63], v3 offset:23552
  v_mfma_f32_32x32x16_bf16 v[16:31], a[84:87], v[52:55], v[16:31]
  ds_read_b128 v[48:51], v3 offset:24576
  ds_write_b128 v79, v[36:39]
  s_waitcnt lgkmcnt(2)
  v_mfma_f32_32x32x16_bf16 v[16:31], a[88:91], v[56:59], v[16:31]
  ds_read_b128 v[52:55], v3 offset:25600
  ds_read_b128 v[68:71], v4 offset:0
  v_mfma_f32_32x32x16_bf16 v[16:31], a[92:95], v[60:63], v[16:31]
  ds_read_b128 v[56:59], v3 offset:26624
  v_mov_b32 v11, 1
  v_mov_b32 v10, 163328
  s_mov_b64 exec, 1
  ds_add_u32 v10, v11 offset:44
  s_mov_b64 exec, -1
  s_waitcnt lgkmcnt(3)
  v_mfma_f32_32x32x16_bf16 v[16:31], a[96:99], v[48:51], v[16:31]
  ds_read_b128 v[60:63], v3 offset:27648
  s_waitcnt vmcnt(17)
  v_mfma_f32_32x32x16_bf16 v[16:31], a[100:103], v[52:55], v[16:31]
  s_waitcnt lgkmcnt(0)
  s_waitcnt vmcnt(16)
  v_mfma_f32_32x32x16_bf16 v[16:31], a[104:107], v[56:59], v[16:31]
  s_waitcnt vmcnt(15)
  v_mfma_f32_32x32x16_bf16 v[16:31], a[108:111], v[60:63], v[16:31]
  v_accvgpr_write_b32 a116, v71
  v_accvgpr_write_b32 a117, v71
  v_accvgpr_write_b32 a118, v71
  v_accvgpr_write_b32 a119, v71
  s_waitcnt vmcnt(14)
  s_nop 0
  v_mfma_f32_32x32x16_bf16 v[16:31], a[112:115], a[116:119], v[16:31]
  s_setprio 1
  s_nop 10
  v_mul_f32 v64, v16, v16
  v_mul_f32 v65, v17, v17
  v_mul_f32 v66, v18, v18
  v_mul_f32 v67, v19, v19
  v_fma_f32 v64, v64, v70, v69
  v_fma_f32 v65, v65, v70, v69
  v_fma_f32 v66, v66, v70, v69
  v_fma_f32 v67, v67, v70, v69
  v_mul_f32 v64, v64, v16
  v_mul_f32 v65, v65, v17
  v_mul_f32 v66, v66, v18
  v_mul_f32 v67, v67, v19
  v_exp_f32 v64, v64
  v_exp_f32 v65, v65
  v_exp_f32 v66, v66
  v_exp_f32 v67, v67
  v_fma_f32 v64, v64, v68, v68
  v_fma_f32 v65, v65, v68, v68
  v_fma_f32 v66, v66, v68, v68
  v_fma_f32 v67, v67, v68, v68
  v_rcp_f32 v64, v64
  v_rcp_f32 v65, v65
  v_rcp_f32 v66, v66
  v_rcp_f32 v67, v67
  v_mul_f32 v64, v64, v16
  v_mul_f32 v65, v65, v17
  v_mul_f32 v66, v66, v18
  v_mul_f32 v67, v67, v19
  v_cvt_pk_bf16_f32 v72, v64, v65
  v_cvt_pk_bf16_f32 v73, v66, v67
  v_mul_f32 v64, v20, v20
  v_mul_f32 v65, v21, v21
  v_mul_f32 v66, v22, v22
  v_mul_f32 v67, v23, v23
  v_fma_f32 v64, v64, v70, v69
  v_fma_f32 v65, v65, v70, v69
  v_fma_f32 v66, v66, v70, v69
  v_fma_f32 v67, v67, v70, v69
  v_mul_f32 v64, v64, v20
  v_mul_f32 v65, v65, v21
  v_mul_f32 v66, v66, v22
  v_mul_f32 v67, v67, v23
  v_exp_f32 v64, v64
  v_exp_f32 v65, v65
  v_exp_f32 v66, v66
  v_exp_f32 v67, v67
  v_fma_f32 v64, v64, v68, v68
  v_fma_f32 v65, v65, v68, v68
  v_fma_f32 v66, v66, v68, v68
  v_fma_f32 v67, v67, v68, v68
  v_rcp_f32 v64, v64
  v_rcp_f32 v65, v65
  v_rcp_f32 v66, v66
  v_rcp_f32 v67, v67
  v_mul_f32 v64, v64, v20
  v_mul_f32 v65, v65, v21
  v_mul_f32 v66, v66, v22
  v_mul_f32 v67, v67, v23
  v_cvt_pk_bf16_f32 v74, v64, v65
  v_cvt_pk_bf16_f32 v75, v66, v67
  buffer_store_dwordx4 v[72:75], v1, s[4:7], s80 offen offset:0 sc1
  v_mul_f32 v64, v24, v24
  v_mul_f32 v65, v25, v25
  v_mul_f32 v66, v26, v26
  v_mul_f32 v67, v27, v27
  v_fma_f32 v64, v64, v70, v69
  v_fma_f32 v65, v65, v70, v69
  v_fma_f32 v66, v66, v70, v69
  v_fma_f32 v67, v67, v70, v69
  v_mul_f32 v64, v64, v24
  v_mul_f32 v65, v65, v25
  v_mul_f32 v66, v66, v26
  v_mul_f32 v67, v67, v27
  v_exp_f32 v64, v64
  v_exp_f32 v65, v65
  v_exp_f32 v66, v66
  v_exp_f32 v67, v67
  v_fma_f32 v64, v64, v68, v68
  v_fma_f32 v65, v65, v68, v68
  v_fma_f32 v66, v66, v68, v68
  v_fma_f32 v67, v67, v68, v68
  v_rcp_f32 v64, v64
  v_rcp_f32 v65, v65
  v_rcp_f32 v66, v66
  v_rcp_f32 v67, v67
  v_mul_f32 v64, v64, v24
  v_mul_f32 v65, v65, v25
  v_mul_f32 v66, v66, v26
  v_mul_f32 v67, v67, v27
  v_cvt_pk_bf16_f32 v76, v64, v65
  v_cvt_pk_bf16_f32 v77, v66, v67
  v_mul_f32 v64, v28, v28
  v_mul_f32 v65, v29, v29
  v_mul_f32 v66, v30, v30
  v_mul_f32 v67, v31, v31
  v_fma_f32 v64, v64, v70, v69
  v_fma_f32 v65, v65, v70, v69
  v_fma_f32 v66, v66, v70, v69
  v_fma_f32 v67, v67, v70, v69
  v_mul_f32 v64, v64, v28
  v_mul_f32 v65, v65, v29
  v_mul_f32 v66, v66, v30
  v_mul_f32 v67, v67, v31
  v_exp_f32 v64, v64
  v_exp_f32 v65, v65
  v_exp_f32 v66, v66
  v_exp_f32 v67, v67
  v_fma_f32 v64, v64, v68, v68
  v_fma_f32 v65, v65, v68, v68
  v_fma_f32 v66, v66, v68, v68
  v_fma_f32 v67, v67, v68, v68
  v_rcp_f32 v64, v64
  v_rcp_f32 v65, v65
  v_rcp_f32 v66, v66
  v_rcp_f32 v67, v67
  v_mul_f32 v64, v64, v28
  v_mul_f32 v65, v65, v29
  v_mul_f32 v66, v66, v30
  v_mul_f32 v67, v67, v31
  v_cvt_pk_bf16_f32 v78, v64, v65
  v_cvt_pk_bf16_f32 v79, v66, v67
  buffer_store_dwordx4 v[76:79], v1, s[4:7], s80 offen offset:2048 sc1
  s_lshl_b32 s55, s91, 11
  s_add_u32 s55, s55, 131072 + 2048
  v_add_u32 v13, s55, v2
  ds_write_b128 v13, v[72:75]
  ds_write_b128 v13, v[76:79] offset:1024
  ds_read_b128 v[68:71], v4 offset:512
  s_setprio 1
  ds_read_b128 v[48:51], v3 offset:28672
  ds_read_b128 v[52:55], v3 offset:29696
  ds_read_b128 v[56:59], v3 offset:30720
  s_waitcnt lgkmcnt(1)
  v_mfma_f32_32x32x16_bf16 v[32:47], a[0:3], v[48:51], 0
  ds_read_b128 v[60:63], v3 offset:31744
  v_mfma_f32_32x32x16_bf16 v[32:47], a[4:7], v[52:55], v[32:47]
  ds_read_b128 v[48:51], v3 offset:32768
  s_waitcnt lgkmcnt(1)
  v_mfma_f32_32x32x16_bf16 v[32:47], a[8:11], v[56:59], v[32:47]
  ds_read_b128 v[52:55], v3 offset:33792
  v_mfma_f32_32x32x16_bf16 v[32:47], a[12:15], v[60:63], v[32:47]
  ds_read_b128 v[56:59], v3 offset:34816
  s_add_u32 s95, s77, s15
  buffer_load_dwordx4 a[0:3], v2, s[4:7], s95 offen offset:2048 sc1
  s_waitcnt lgkmcnt(1)
  v_mfma_f32_32x32x16_bf16 v[32:47], a[16:19], v[48:51], v[32:47]
  ds_read_b128 v[60:63], v3 offset:35840
  v_mfma_f32_32x32x16_bf16 v[32:47], a[20:23], v[52:55], v[32:47]
  ds_read_b128 v[48:51], v3 offset:36864
  s_waitcnt lgkmcnt(1)
  v_mfma_f32_32x32x16_bf16 v[32:47], a[24:27], v[56:59], v[32:47]
  ds_read_b128 v[52:55], v3 offset:37888
  s_add_u32 s95, s77, s15
  buffer_load_dwordx4 a[4:7], v2, s[4:7], s95 offen offset:3072 sc1
  v_accvgpr_write_b32 a116, v71
  v_accvgpr_write_b32 a117, v71
  v_accvgpr_write_b32 a118, v71
  v_accvgpr_write_b32 a119, v71
  v_mfma_f32_32x32x16_bf16 v[32:47], a[28:31], v[60:63], v[32:47]
  ds_read_b128 v[56:59], v3 offset:38912
  s_waitcnt lgkmcnt(1)
  v_mfma_f32_32x32x16_bf16 v[32:47], a[32:35], v[48:51], v[32:47]
  ds_read_b128 v[60:63], v3 offset:39936
  v_mfma_f32_32x32x16_bf16 v[32:47], a[36:39], v[52:55], v[32:47]
  ds_read_b128 v[48:51], v3 offset:40960
  s_add_u32 s95, s77, s81
  buffer_load_dwordx4 a[8:11], v2, s[4:7], s95 offen offset:0 sc1
  s_waitcnt lgkmcnt(1)
  v_mfma_f32_32x32x16_bf16 v[32:47], a[40:43], v[56:59], v[32:47]
  ds_read_b128 v[52:55], v3 offset:41984
  v_mfma_f32_32x32x16_bf16 v[32:47], a[44:47], v[60:63], v[32:47]
  ds_read_b128 v[56:59], v3 offset:43008
  s_waitcnt lgkmcnt(1)
  v_mfma_f32_32x32x16_bf16 v[32:47], a[48:51], v[48:51], v[32:47]
  ds_read_b128 v[60:63], v3 offset:44032
  s_add_u32 s95, s77, s81
  buffer_load_dwordx4 a[12:15], v2, s[4:7], s95 offen offset:1024 sc1
  v_mfma_f32_32x32x16_bf16 v[32:47], a[52:55], v[52:55], v[32:47]
  ds_read_b128 v[48:51], v3 offset:45056
  s_waitcnt lgkmcnt(1)
  v_mfma_f32_32x32x16_bf16 v[32:47], a[56:59], v[56:59], v[32:47]
  ds_read_b128 v[52:55], v3 offset:46080
  v_mfma_f32_32x32x16_bf16 v[32:47], a[60:63], v[60:63], v[32:47]
  ds_read_b128 v[56:59], v3 offset:47104
  s_add_u32 s95, s77, s81
  buffer_load_dwordx4 a[16:19], v2, s[4:7], s95 offen offset:2048 sc1
  s_waitcnt lgkmcnt(1)
  v_mfma_f32_32x32x16_bf16 v[32:47], a[64:67], v[48:51], v[32:47]
  ds_read_b128 v[60:63], v3 offset:48128
  v_mfma_f32_32x32x16_bf16 v[32:47], a[68:71], v[52:55], v[32:47]
  ds_read_b128 v[48:51], v3 offset:49152
  s_waitcnt lgkmcnt(1)
  v_mfma_f32_32x32x16_bf16 v[32:47], a[72:75], v[56:59], v[32:47]
  ds_read_b128 v[52:55], v3 offset:50176
  s_add_u32 s95, s77, s81
  buffer_load_dwordx4 a[20:23], v2, s[4:7], s95 offen offset:3072 sc1
  v_mfma_f32_32x32x16_bf16 v[32:47], a[76:79], v[60:63], v[32:47]
  ds_read_b128 v[56:59], v3 offset:51200
  s_waitcnt lgkmcnt(1)
  v_mfma_f32_32x32x16_bf16 v[32:47], a[80:83], v[48:51], v[32:47]
  ds_read_b128 v[60:63], v3 offset:52224
  s_waitcnt vmcnt(6)
  s_mov_b64 exec, 0x7f
  buffer_store_dwordx2 v[8:9], v5, s[4:7], 0 offen offset:2048 sc1
  s_mov_b64 exec, -1
  v_mfma_f32_32x32x16_bf16 v[32:47], a[84:87], v[52:55], v[32:47]
  ds_read_b128 v[48:51], v3 offset:53248
  s_add_u32 s95, s77, s82
  buffer_load_dwordx4 a[24:27], v2, s[4:7], s95 offen offset:0 sc1
  s_waitcnt lgkmcnt(1)
  v_mfma_f32_32x32x16_bf16 v[32:47], a[88:91], v[56:59], v[32:47]
  ds_read_b128 v[52:55], v3 offset:54272
  v_mfma_f32_32x32x16_bf16 v[32:47], a[92:95], v[60:63], v[32:47]
  ds_read_b128 v[56:59], v3 offset:55296
  s_waitcnt lgkmcnt(1)
  v_mfma_f32_32x32x16_bf16 v[32:47], a[96:99], v[48:51], v[32:47]
  ds_read_b128 v[60:63], v3 offset:56320
  s_add_u32 s95, s77, s82
  buffer_load_dwordx4 a[28:31], v2, s[4:7], s95 offen offset:1024 sc1
  v_mfma_f32_32x32x16_bf16 v[32:47], a[100:103], v[52:55], v[32:47]
  s_waitcnt lgkmcnt(0)
  v_mfma_f32_32x32x16_bf16 v[32:47], a[104:107], v[56:59], v[32:47]
  v_mfma_f32_32x32x16_bf16 v[32:47], a[108:111], v[60:63], v[32:47]
  s_add_u32 s95, s77, s82
  buffer_load_dwordx4 a[32:35], v2, s[4:7], s95 offen offset:2048 sc1
  v_mfma_f32_32x32x16_bf16 v[32:47], a[112:115], a[116:119], v[32:47]
  s_setprio 1
  v_and_b32 v48, 31, v0
  v_lshrrev_b32 v49, 5, v0
  v_mul_u32_u24 v49, 28672, v49
  v_lshl_add_u32 v49, v48, 4, v49
  s_lshl_b32 s55, s51, 12
  s_lshl_b32 s56, s91, 9
  s_add_u32 s55, s55, s56
  s_add_u32 s55, s55, 47104
  v_add_u32 v49, s55, v49
  s_nop 1
  v_mul_f32 v64, v32, v32
  v_mul_f32 v65, v33, v33
  v_mul_f32 v66, v34, v34
  v_mul_f32 v67, v35, v35
  v_fma_f32 v64, v64, v70, v69
  v_fma_f32 v65, v65, v70, v69
  v_fma_f32 v66, v66, v70, v69
  v_fma_f32 v67, v67, v70, v69
  v_mul_f32 v64, v64, v32
  v_mul_f32 v65, v65, v33
  v_mul_f32 v66, v66, v34
  v_mul_f32 v67, v67, v35
  ds_read_b128 a[112:115], v49
  v_mov_b32 v51, 1
  v_mov_b32 v50, 163328
  s_mov_b64 exec, 1
  ds_add_u32 v50, v51 offset:40
  s_mov_b64 exec, -1
  v_exp_f32 v64, v64
  v_exp_f32 v65, v65
  v_exp_f32 v66, v66
  v_exp_f32 v67, v67
  v_fma_f32 v64, v64, v68, v68
  v_fma_f32 v65, v65, v68, v68
  v_fma_f32 v66, v66, v68, v68
  v_fma_f32 v67, v67, v68, v68
  v_rcp_f32 v64, v64
  v_rcp_f32 v65, v65
  v_rcp_f32 v66, v66
  v_rcp_f32 v67, v67
  v_mul_f32 v64, v64, v32
  v_mul_f32 v65, v65, v33
  v_mul_f32 v66, v66, v34
  v_mul_f32 v67, v67, v35
  v_cvt_pk_bf16_f32 v72, v64, v65
  v_cvt_pk_bf16_f32 v73, v66, v67
  v_mul_f32 v64, v36, v36
  v_mul_f32 v65, v37, v37
  v_mul_f32 v66, v38, v38
  v_mul_f32 v67, v39, v39
  v_fma_f32 v64, v64, v70, v69
  v_fma_f32 v65, v65, v70, v69
  v_fma_f32 v66, v66, v70, v69
  v_fma_f32 v67, v67, v70, v69
  v_mul_f32 v64, v64, v36
  v_mul_f32 v65, v65, v37
  v_mul_f32 v66, v66, v38
  v_mul_f32 v67, v67, v39
  v_exp_f32 v64, v64
  v_exp_f32 v65, v65
  v_exp_f32 v66, v66
  v_exp_f32 v67, v67
  v_fma_f32 v64, v64, v68, v68
  v_fma_f32 v65, v65, v68, v68
  v_fma_f32 v66, v66, v68, v68
  v_fma_f32 v67, v67, v68, v68
  v_rcp_f32 v64, v64
  v_rcp_f32 v65, v65
  v_rcp_f32 v66, v66
  v_rcp_f32 v67, v67
  v_mul_f32 v64, v64, v36
  v_mul_f32 v65, v65, v37
  v_mul_f32 v66, v66, v38
  v_mul_f32 v67, v67, v39
  v_cvt_pk_bf16_f32 v74, v64, v65
  v_cvt_pk_bf16_f32 v75, v66, v67
  buffer_store_dwordx4 v[72:75], v1, s[4:7], s80 offen offset:512 sc1
  v_mul_f32 v64, v40, v40
  v_mul_f32 v65, v41, v41
  v_mul_f32 v66, v42, v42
  v_mul_f32 v67, v43, v43
  v_fma_f32 v64, v64, v70, v69
  v_fma_f32 v65, v65, v70, v69
  v_fma_f32 v66, v66, v70, v69
  v_fma_f32 v67, v67, v70, v69
  v_mul_f32 v64, v64, v40
  v_mul_f32 v65, v65, v41
  v_mul_f32 v66, v66, v42
  v_mul_f32 v67, v67, v43
  v_exp_f32 v64, v64
  v_exp_f32 v65, v65
  v_exp_f32 v66, v66
  v_exp_f32 v67, v67
  v_fma_f32 v64, v64, v68, v68
  v_fma_f32 v65, v65, v68, v68
  v_fma_f32 v66, v66, v68, v68
  v_fma_f32 v67, v67, v68, v68
  v_rcp_f32 v64, v64
  v_rcp_f32 v65, v65
  v_rcp_f32 v66, v66
  v_rcp_f32 v67, v67
  v_mul_f32 v64, v64, v40
  v_mul_f32 v65, v65, v41
  v_mul_f32 v66, v66, v42
  v_mul_f32 v67, v67, v43
  s_load_dwordx16 s[16:31], s[46:47], s62 glc
  v_cvt_pk_bf16_f32 v76, v64, v65
  v_cvt_pk_bf16_f32 v77, v66, v67
  v_mul_f32 v64, v44, v44
  v_mul_f32 v65, v45, v45
  v_mul_f32 v66, v46, v46
  v_mul_f32 v67, v47, v47
  v_fma_f32 v64, v64, v70, v69
  v_fma_f32 v65, v65, v70, v69
  v_fma_f32 v66, v66, v70, v69
  v_fma_f32 v67, v67, v70, v69
  v_mul_f32 v64, v64, v44
  v_mul_f32 v65, v65, v45
  v_mul_f32 v66, v66, v46
  v_mul_f32 v67, v67, v47
  v_exp_f32 v64, v64
  v_exp_f32 v65, v65
  v_exp_f32 v66, v66
  v_exp_f32 v67, v67
  v_fma_f32 v64, v64, v68, v68
  v_fma_f32 v65, v65, v68, v68
  v_fma_f32 v66, v66, v68, v68
  v_fma_f32 v67, v67, v68, v68
  v_rcp_f32 v64, v64
  v_rcp_f32 v65, v65
  v_rcp_f32 v66, v66
  v_rcp_f32 v67, v67
  v_mul_f32 v64, v64, v44
  v_mul_f32 v65, v65, v45
  v_mul_f32 v66, v66, v46
  v_mul_f32 v67, v67, v47
  v_cvt_pk_bf16_f32 v78, v64, v65
  v_cvt_pk_bf16_f32 v79, v66, v67
  buffer_store_dwordx4 v[76:79], v1, s[4:7], s80 offen offset:2560 sc1
  s_setprio 0
  s_lshl_b32 s55, s50, 6
  v_add_u32 v14, s55, v0
  v_mul_u32_u24 v14, 896, v14
  s_lshl_b32 s55, s51, 7
  s_lshl_b32 s56, s91, 4
  s_add_u32 s55, s55, s56
  v_add_u32 v14, s55, v14
  v_lshrrev_b32 v49, 5, v0
  v_lshlrev_b32 v15, 11, v49
  v_lshl_add_u32 v15, v48, 4, v15
  s_lshl_b32 s55, s91, 14
  v_add_u32 v15, s55, v15
  s_lshl_b32 s55, s91, 11
  v_add_u32 v4, s55, v2
  v_bfe_u32 v3, v0, 2, 2
  v_lshlrev_b32 v3, 7, v3
  v_lshrrev_b32 v49, 4, v0
  v_lshl_add_u32 v3, v49, 5, v3
  v_and_b32 v49, 3, v0
  v_lshl_add_u32 v3, v49, 3, v3
  s_lshl_b32 s65, s91, 10
  s_add_u32 s65, s65, 153600
  v_add_u32 v3, s65, v3
  s_lshl_b32 s55, s51, 6
  s_lshl_b32 s56, s91, 3
  s_add_u32 s55, s55, s56
  s_mul_i32 s55, s55, 4224
  s_lshl_b32 s56, s50, 6
  s_add_u32 s55, s55, s56
  s_add_u32 s64, s55, 9437184
  ds_read_b128 a[56:59], v13
  ds_read_b128 a[60:63], v13 offset:1024
  v_accvgpr_write_b32 a80, v72
  v_accvgpr_write_b32 a81, v73
  v_accvgpr_write_b32 a82, v74
  v_accvgpr_write_b32 a83, v75
  v_accvgpr_write_b32 a84, v76
  v_accvgpr_write_b32 a85, v77
  v_accvgpr_write_b32 a86, v78
  v_accvgpr_write_b32 a87, v79
  s_mov_b32 s61, 0
  s_waitcnt lgkmcnt(0)
  s_cmp_lg_u64 s[16:17], s[48:49]
  s_cselect_b32 s95, 1, 0
  s_cmp_lg_u64 s[18:19], s[48:49]
  s_addc_u32 s95, s95, 0
  s_cmp_lg_u64 s[20:21], s[48:49]
  s_addc_u32 s95, s95, 0
  s_cmp_lg_u64 s[22:23], s[48:49]
  s_addc_u32 s95, s95, 0
  s_cmp_lg_u64 s[24:25], s[48:49]
  s_addc_u32 s95, s95, 0
  s_cmp_lg_u64 s[26:27], s[48:49]
  s_addc_u32 s95, s95, 0
  s_cmp_lg_u64 s[28:29], s[48:49]
  s_addc_u32 s95, s95, 0
  s_cmp_eq_u32 s95, 0
  s_cbranch_scc0 SSLOW_34
SBACK_35:
  s_add_u32 s95, s83, s13
  buffer_load_dwordx4 a[64:67], v1, s[4:7], s95 offen offset:0 sc1
  s_add_u32 s95, s83, s13
  buffer_load_dwordx4 a[68:71], v1, s[4:7], s95 offen offset:2048 sc1
  s_add_u32 s95, s83, s14
  buffer_load_dwordx4 a[72:75], v1, s[4:7], s95 offen offset:0 sc1
  s_add_u32 s95, s83, s14
  buffer_load_dwordx4 a[76:79], v1, s[4:7], s95 offen offset:2048 sc1
  s_add_u32 s95, s83, s15
  buffer_load_dwordx4 v[48:51], v1, s[4:7], s95 offen offset:0 sc1
  s_add_u32 s95, s83, s15
  buffer_load_dwordx4 v[52:55], v1, s[4:7], s95 offen offset:2048 sc1
  s_add_u32 s95, s83, s81
  buffer_load_dwordx4 v[56:59], v1, s[4:7], s95 offen offset:0 sc1
  s_cmp_eq_u32 s61, 1
  s_cbranch_scc1 SG_36
  s_waitcnt vmcnt(7)
  s_mov_b64 exec, 0x7f
  buffer_store_dwordx2 v[8:9], v5, s[4:7], 0 offen offset:2560 sc1
  s_mov_b64 exec, -1
SG_36:
  v_mov_b32 v10, 0
  s_or_b32 s55, s2, s91
  s_cmp_eq_u32 s55, 0
  s_cselect_b64 exec, 1, 0
  buffer_store_dwordx2 v[8:9], v10, s[4:7], 0 offen sc1
  s_mov_b64 exec, -1
  v_mfma_f32_32x32x16_bf16 v[16:31], v[80:83], a[56:59], 0
  v_mfma_f32_32x32x16_bf16 v[32:47], v[84:87], a[56:59], 0
  s_add_u32 s95, s83, s81
  buffer_load_dwordx4 v[60:63], v1, s[4:7], s95 offen offset:2048 sc1
  s_add_u32 s95, s77, s82
  buffer_load_dwordx4 a[36:39], v2, s[4:7], s95 offen offset:3072 sc1
  s_add_u32 s95, s77, s3
  buffer_load_dwordx4 a[40:43], v2, s[4:7], s95 offen offset:0 sc1
  v_mfma_f32_32x32x16_bf16 v[16:31], v[88:91], a[60:63], v[16:31]
  v_mfma_f32_32x32x16_bf16 v[32:47], v[92:95], a[60:63], v[32:47]
  s_add_u32 s95, s83, s82
  buffer_load_dwordx4 v[64:67], v1, s[4:7], s95 offen offset:0 sc1
  s_add_u32 s95, s77, s3
  buffer_load_dwordx4 a[44:47], v2, s[4:7], s95 offen offset:1024 sc1
  s_add_u32 s95, s77, s3
  buffer_load_dwordx4 a[48:51], v2, s[4:7], s95 offen offset:2048 sc1
  s_waitcnt vmcnt(12)
  v_mfma_f32_32x32x16_bf16 v[16:31], v[96:99], a[64:67], v[16:31]
  v_mfma_f32_32x32x16_bf16 v[32:47], v[100:103], a[64:67], v[32:47]
  s_add_u32 s95, s83, s82
  buffer_load_dwordx4 v[68:71], v1, s[4:7], s95 offen offset:2048 sc1
  s_add_u32 s95, s77, s3
  buffer_load_dwordx4 a[52:55], v2, s[4:7], s95 offen offset:3072 sc1
  s_add_u32 s95, s83, s3
  buffer_load_dwordx4 v[72:75], v1, s[4:7], s95 offen offset:0 sc1
  s_waitcnt vmcnt(14)
  v_mfma_f32_32x32x16_bf16 v[16:31], v[104:107], a[68:71], v[16:31]
  v_mfma_f32_32x32x16_bf16 v[32:47], v[108:111], a[68:71], v[32:47]
  s_add_u32 s95, s83, s3
  buffer_load_dwordx4 v[76:79], v1, s[4:7], s95 offen offset:2048 sc1
  s_waitcnt vmcnt(14)
  v_mfma_f32_32x32x16_bf16 v[16:31], v[112:115], a[72:75], v[16:31]
  v_mfma_f32_32x32x16_bf16 v[32:47], v[116:119], a[72:75], v[32:47]
  s_waitcnt vmcnt(13)
  v_mfma_f32_32x32x16_bf16 v[16:31], v[120:123], a[76:79], v[16:31]
  v_mfma_f32_32x32x16_bf16 v[32:47], v[124:127], a[76:79], v[32:47]
  s_mov_b64 exec, s[84:85]
  buffer_load_dwordx2 v[10:11], v6, s[4:7], 0 offen offset:640 sc1
  s_mov_b64 exec, -1
  s_add_u32 s95, s62, 512
  s_load_dwordx16 s[16:31], s[46:47], s95 glc
  s_waitcnt vmcnt(13)
  v_mfma_f32_32x32x16_bf16 v[16:31], v[128:131], v[48:51], v[16:31]
  v_mfma_f32_32x32x16_bf16 v[32:47], v[132:135], v[48:51], v[32:47]
  s_waitcnt vmcnt(12)
  v_mfma_f32_32x32x16_bf16 v[16:31], a[0:3], v[52:55], v[16:31]
  v_mfma_f32_32x32x16_bf16 v[32:47], a[4:7], v[52:55], v[32:47]
  s_waitcnt vmcnt(11)
  v_mfma_f32_32x32x16_bf16 v[16:31], a[8:11], v[56:59], v[16:31]
  v_mfma_f32_32x32x16_bf16 v[32:47], a[12:15], v[56:59], v[32:47]
  s_waitcnt lgkmcnt(0)
  s_cmp_lg_u64 s[16:17], s[48:49]
  s_cselect_b32 s95, 1, 0
  s_cmp_lg_u64 s[18:19], s[48:49]
  s_addc_u32 s95, s95, 0
  s_cmp_lg_u64 s[20:21], s[48:49]
  s_addc_u32 s95, s95, 0
  s_cmp_lg_u64 s[22:23], s[48:49]
  s_addc_u32 s95, s95, 0
  s_cmp_lg_u64 s[24:25], s[48:49]
  s_addc_u32 s95, s95, 0
  s_cmp_lg_u64 s[26:27], s[48:49]
  s_addc_u32 s95, s95, 0
  s_cmp_lg_u64 s[28:29], s[48:49]
  s_addc_u32 s95, s95, 0
  s_cmp_eq_u32 s95, 0
  s_cbranch_scc0 SSLOW_37
SBACK_38:
  s_add_u32 s95, s83, s13
  buffer_load_dwordx4 a[88:91], v1, s[4:7], s95 offen offset:512 sc1
  s_add_u32 s95, s83, s13
  buffer_load_dwordx4 a[92:95], v1, s[4:7], s95 offen offset:2560 sc1
  s_add_u32 s95, s83, s14
  buffer_load_dwordx4 a[96:99], v1, s[4:7], s95 offen offset:512 sc1
  s_add_u32 s95, s83, s14
  buffer_load_dwordx4 a[100:103], v1, s[4:7], s95 offen offset:2560 sc1
  s_waitcnt vmcnt(14)
  v_mfma_f32_32x32x16_bf16 v[16:31], a[16:19], v[60:63], v[16:31]
  v_mfma_f32_32x32x16_bf16 v[32:47], a[20:23], v[60:63], v[32:47]
  s_add_u32 s95, s83, s15
  buffer_load_dwordx4 a[104:107], v1, s[4:7], s95 offen offset:512 sc1
  s_add_u32 s95, s83, s15
  buffer_load_dwordx4 a[108:111], v1, s[4:7], s95 offen offset:2560 sc1
  s_add_u32 s95, s83, s81
  buffer_load_dwordx4 a[56:59], v1, s[4:7], s95 offen offset:512 sc1
  s_add_u32 s95, s83, s81
  buffer_load_dwordx4 a[60:63], v1, s[4:7], s95 offen offset:2560 sc1
  s_waitcnt vmcnt(15)
  v_mfma_f32_32x32x16_bf16 v[16:31], a[24:27], v[64:67], v[16:31]
  v_mfma_f32_32x32x16_bf16 v[32:47], a[28:31], v[64:67], v[32:47]
  s_add_u32 s95, s83, s82
  buffer_load_dwordx4 a[64:67], v1, s[4:7], s95 offen offset:512 sc1
  s_add_u32 s95, s83, s82
  buffer_load_dwordx4 a[68:71], v1, s[4:7], s95 offen offset:2560 sc1
  s_add_u32 s95, s83, s3
  buffer_load_dwordx4 a[72:75], v1, s[4:7], s95 offen offset:512 sc1
  s_add_u32 s95, s83, s3
  buffer_load_dwordx4 a[76:79], v1, s[4:7], s95 offen offset:2560 sc1
  s_waitcnt vmcnt(16)
  v_mfma_f32_32x32x16_bf16 v[16:31], a[32:35], v[68:71], v[16:31]
  v_mfma_f32_32x32x16_bf16 v[32:47], a[36:39], v[68:71], v[32:47]
  s_waitcnt vmcnt(14)
  v_mfma_f32_32x32x16_bf16 v[16:31], a[40:43], v[72:75], v[16:31]
  v_mfma_f32_32x32x16_bf16 v[32:47], a[44:47], v[72:75], v[32:47]
  s_waitcnt vmcnt(13)
  v_mfma_f32_32x32x16_bf16 v[16:31], a[48:51], v[76:79], v[16:31]
  v_mfma_f32_32x32x16_bf16 v[32:47], a[52:55], v[76:79], v[32:47]
  s_waitcnt vmcnt(12)
  s_mov_b64 exec, s[84:85]
  v_cmp_ne_u64 vcc, v[10:11], v[8:9]
  s_cbranch_vccnz PSLOW_39
PBACK_40:
  s_mov_b64 exec, -1
  v_lshrrev_b32 v10, 3, v0
  v_mul_u32_u24 v10, 4224, v10
  v_bfe_u32 v11, v0, 1, 1
  v_lshl_add_u32 v10, v11, 11, v10
  v_bfe_u32 v11, v0, 2, 1
  v_lshl_add_u32 v10, v11, 5, v10
  v_and_b32 v11, 1, v0
  v_lshl_add_u32 v10, v11, 4, v10
  s_mov_b32 m0, s65
  s_nop 0
  buffer_load_dwordx4 v10, s[4:7], s64 offen sc1 lds
  v_mov_b32 v10, 163328
  s_mov_b32 s96, 400000
LB_41:
  ds_read_b32 v11, v10 offset:40
  s_waitcnt lgkmcnt(0)
  v_readfirstlane_b32 s55, v11
  s_nop 0
  s_cmp_ge_u32 s55, 8
  s_cbranch_scc1 LBD_42
  s_sub_u32 s96, s96, 1
  s_cmp_lg_u32 s96, 0
  s_cbranch_scc1 LB_41
  s_or_b32 s97, s97, 2048
LBD_42:
  v_mfma_f32_32x32x16_bf16 v[48:63], v[80:83], a[80:83], 0
  v_mfma_f32_32x32x16_bf16 v[64:79], v[84:87], a[80:83], 0
  v_mfma_f32_32x32x16_bf16 v[48:63], v[88:91], a[84:87], v[48:63]
  ds_write_b128 v15, v[16:19] offset:0
  v_mfma_f32_32x32x16_bf16 v[64:79], v[92:95], a[84:87], v[64:79]
  s_waitcnt vmcnt(12)
  v_mfma_f32_32x32x16_bf16 v[48:63], v[96:99], a[88:91], v[48:63]
  ds_write_b128 v15, v[20:23] offset:1024
  v_mfma_f32_32x32x16_bf16 v[64:79], v[100:103], a[88:91], v[64:79]
  s_waitcnt vmcnt(11)
  v_mfma_f32_32x32x16_bf16 v[48:63], v[104:107], a[92:95], v[48:63]
  v_mfma_f32_32x32x16_bf16 v[64:79], v[108:111], a[92:95], v[64:79]
  ds_write_b128 v15, v[24:27] offset:4096
  s_waitcnt vmcnt(10)
  v_mfma_f32_32x32x16_bf16 v[48:63], v[112:115], a[96:99], v[48:63]
  v_mfma_f32_32x32x16_bf16 v[64:79], v[116:119], a[96:99], v[64:79]
  s_waitcnt vmcnt(9)
  v_mfma_f32_32x32x16_bf16 v[48:63], v[120:123], a[100:103], v[48:63]
  ds_write_b128 v15, v[28:31] offset:5120
  v_mfma_f32_32x32x16_bf16 v[64:79], v[124:127], a[100:103], v[64:79]
  s_waitcnt vmcnt(8)
  v_mfma_f32_32x32x16_bf16 v[48:63], v[128:131], a[104:107], v[48:63]
  ds_write_b128 v15, v[32:35] offset:8192
  v_mfma_f32_32x32x16_bf16 v[64:79], v[132:135], a[104:107], v[64:79]
  s_waitcnt vmcnt(7)
  v_mfma_f32_32x32x16_bf16 v[48:63], a[0:3], a[108:111], v[48:63]
  v_mfma_f32_32x32x16_bf16 v[64:79], a[4:7], a[108:111], v[64:79]
  ds_write_b128 v15, v[36:39] offset:9216
  s_waitcnt vmcnt(6)
  v_mfma_f32_32x32x16_bf16 v[48:63], a[8:11], a[56:59], v[48:63]
  v_mfma_f32_32x32x16_bf16 v[64:79], a[12:15], a[56:59], v[64:79]
  global_load_dwordx4 v[80:83], v14, s[100:101]
  s_waitcnt vmcnt(1)
  ds_read_b64_tr_b16 v[84:85], v3 offset:0
  ds_read_b64_tr_b16 v[86:87], v3 offset:512
  v_accvgpr_read_b32 v88, a112
  v_accvgpr_read_b32 v89, a113
  v_accvgpr_read_b32 v90, a114
  v_accvgpr_read_b32 v91, a115
  v_mfma_f32_32x32x16_bf16 v[48:63], a[16:19], a[60:63], v[48:63]
  ds_write_b128 v15, v[40:43] offset:12288
  v_mfma_f32_32x32x16_bf16 v[64:79], a[20:23], a[60:63], v[64:79]
  v_mfma_f32_32x32x16_bf16 v[48:63], a[24:27], a[64:67], v[48:63]
  ds_write_b128 v15, v[44:47] offset:13312
  v_mfma_f32_32x32x16_bf16 v[64:79], a[28:31], a[64:67], v[64:79]
  v_mfma_f32_32x32x16_bf16 v[48:63], a[32:35], a[68:71], v[48:63]
  v_mfma_f32_32x32x16_bf16 v[64:79], a[36:39], a[68:71], v[64:79]
  v_mfma_f32_32x32x16_bf16 v[48:63], a[40:43], a[72:75], v[48:63]
  v_mfma_f32_32x32x16_bf16 v[64:79], a[44:47], a[72:75], v[64:79]
  v_mfma_f32_32x32x16_bf16 v[48:63], a[48:51], a[76:79], v[48:63]
  v_mfma_f32_32x32x16_bf16 v[64:79], a[52:55], a[76:79], v[64:79]
  v_add_u32 v12, 0x10000, v4
  s_waitcnt lgkmcnt(0)
  s_nop 8
  ds_write_b128 v15, v[48:51] offset:512
  ds_write_b128 v15, v[52:55] offset:1536
  ds_write_b128 v15, v[56:59] offset:4608
  ds_write_b128 v15, v[60:63] offset:5632
  ds_write_b128 v15, v[64:67] offset:8704
  ds_write_b128 v15, v[68:71] offset:9728
  ds_write_b128 v15, v[72:75] offset:12800
  ds_write_b128 v15, v[76:79] offset:13824
  s_branch MERGE
YPATH:
  v_and_b32 v60, 15, v0
  v_mul_u32_u24 v61, 1536, v15
  v_lshl_add_u32 v61, v60, 4, v61
  v_bfe_u32 v62, v0, 4, 1
  v_lshl_add_u32 v61, v62, 3, v61
  v_add_u32 v61, s58, v61
  ds_read_b64 v[64:65], v61 offset:512
  ds_read_b64 v[66:67], v61 offset:768
  ds_read_b64 v[68:69], v61 offset:1024
  ds_read_b64 v[70:71], v61 offset:1280
  s_lshl_b32 s55, s54, 11
  s_add_u32 s55, s55, s59
  s_add_u32 s55, s55, 9437184
  s_lshl_b32 s56, s52, 11
  s_add_u32 s56, s56, 153600
  v_lshrrev_b32 v62, 4, v0
  v_lshlrev_b32 v62, 3, v62
  v_lshl_add_u32 v62, v60, 5, v62
  v_add_u32 v62, s56, v62
  v_add_u32 v63, s56, v2
  v_mul_f32 v44, v44, v36
  v_mul_f32 v45, v45, v36
  v_mul_f32 v46, v46, v36
  v_mul_f32 v47, v47, v36
  v_mul_f32 v48, v48, v36
  v_mul_f32 v49, v49, v36
  v_mul_f32 v50, v50, v36
  v_mul_f32 v51, v51, v36
  v_mul_f32 v52, v52, v36
  v_mul_f32 v53, v53, v36
  v_mul_f32 v54, v54, v36
  v_mul_f32 v55, v55, v36
  v_mul_f32 v56, v56, v36
  v_mul_f32 v57, v57, v36
  v_mul_f32 v58, v58, v36
  v_mul_f32 v59, v59, v36
  s_waitcnt lgkmcnt(0)
  v_fma_mix_f32 v44, v64, v37, v44 op_sel:[0,0,0] op_sel_hi:[1,0,0]
  v_fma_mix_f32 v45, v64, v37, v45 op_sel:[1,0,0] op_sel_hi:[1,0,0]
  v_fma_mix_f32 v46, v65, v37, v46 op_sel:[0,0,0] op_sel_hi:[1,0,0]
  v_fma_mix_f32 v47, v65, v37, v47 op_sel:[1,0,0] op_sel_hi:[1,0,0]
  v_fma_mix_f32 v48, v66, v37, v48 op_sel:[0,0,0] op_sel_hi:[1,0,0]
  v_fma_mix_f32 v49, v66, v37, v49 op_sel:[1,0,0] op_sel_hi:[1,0,0]
  v_fma_mix_f32 v50, v67, v37, v50 op_sel:[0,0,0] op_sel_hi:[1,0,0]
  v_fma_mix_f32 v51, v67, v37, v51 op_sel:[1,0,0] op_sel_hi:[1,0,0]
  v_fma_mix_f32 v52, v68, v37, v52 op_sel:[0,0,0] op_sel_hi:[1,0,0]
  v_fma_mix_f32 v53, v68, v37, v53 op_sel:[1,0,0] op_sel_hi:[1,0,0]
  v_fma_mix_f32 v54, v69, v37, v54 op_sel:[0,0,0] op_sel_hi:[1,0,0]
  v_fma_mix_f32 v55, v69, v37, v55 op_sel:[1,0,0] op_sel_hi:[1,0,0]
  v_fma_mix_f32 v56, v70, v37, v56 op_sel:[0,0,0] op_sel_hi:[1,0,0]
  v_fma_mix_f32 v57, v70, v37, v57 op_sel:[1,0,0] op_sel_hi:[1,0,0]
  v_fma_mix_f32 v58, v71, v37, v58 op_sel:[0,0,0] op_sel_hi:[1,0,0]
  v_fma_mix_f32 v59, v71, v37, v59 op_sel:[1,0,0] op_sel_hi:[1,0,0]
  v_cvt_pk_bf16_f32 v72, v44, v45
  v_cvt_pk_bf16_f32 v73, v46, v47
  v_cvt_pk_bf16_f32 v74, v48, v49
  v_cvt_pk_bf16_f32 v75, v50, v51
  v_cvt_pk_bf16_f32 v76, v52, v53
  v_cvt_pk_bf16_f32 v77, v54, v55
  v_cvt_pk_bf16_f32 v78, v56, v57
  v_cvt_pk_bf16_f32 v79, v58, v59
  ds_write_b64 v62, v[72:73] offset:0
  ds_write_b64 v62, v[74:75] offset:512
  ds_write_b64 v62, v[76:77] offset:1024
  ds_write_b64 v62, v[78:79] offset:1536
  ds_read_b128 v[64:67], v63 offset:0
  ds_read_b128 v[68:71], v63 offset:1024
  s_waitcnt lgkmcnt(0)
  buffer_store_dwordx4 v[64:67], v2, s[4:7], s55 offen offset:0 sc1
  buffer_store_dwordx4 v[68:71], v2, s[4:7], s55 offen offset:1024 sc1
  buffer_load_dwordx4 a[112:115], v12, s[4:7], s76 offen offset:0 sc1
  v_mov_b32 v12, v2
  ds_read_b128 v[48:51], v3 offset:0
  ds_read_b128 v[52:55], v3 offset:1024
  ds_read_b128 v[56:59], v3 offset:2048
  s_waitcnt lgkmcnt(1)
  v_mfma_f32_32x32x16_bf16 v[16:31], a[0:3], v[48:51], 0
  ds_read_b128 v[60:63], v3 offset:3072
  s_add_u32 s95, s77, s12
  buffer_load_dwordx4 v[80:83], v2, s[4:7], s95 offen offset:0 sc1
  v_mfma_f32_32x32x16_bf16 v[16:31], a[4:7], v[52:55], v[16:31]
  ds_read_b128 v[48:51], v3 offset:4096
  s_waitcnt lgkmcnt(1)
  v_mfma_f32_32x32x16_bf16 v[16:31], a[8:11], v[56:59], v[16:31]
  ds_read_b128 v[52:55], v3 offset:5120
  s_add_u32 s95, s77, s12
  buffer_load_dwordx4 v[84:87], v2, s[4:7], s95 offen offset:1024 sc1
  v_mfma_f32_32x32x16_bf16 v[16:31], a[12:15], v[60:63], v[16:31]
  ds_read_b128 v[56:59], v3 offset:6144
  s_waitcnt lgkmcnt(1)
  v_mfma_f32_32x32x16_bf16 v[16:31], a[16:19], v[48:51], v[16:31]
  ds_read_b128 v[60:63], v3 offset:7168
  s_add_u32 s95, s77, s12
  buffer_load_dwordx4 v[88:91], v2, s[4:7], s95 offen offset:2048 sc1
  v_mfma_f32_32x32x16_bf16 v[16:31], a[20:23], v[52:55], v[16:31]
  ds_read_b128 v[48:51], v3 offset:8192
  s_waitcnt lgkmcnt(1)
  v_mfma_f32_32x32x16_bf16 v[16:31], a[24:27], v[56:59], v[16:31]
  ds_read_b128 v[52:55], v3 offset:9216
  s_add_u32 s95, s77, s12
  buffer_load_dwordx4 v[92:95], v2, s[4:7], s95 offen offset:3072 sc1
  v_mfma_f32_32x32x16_bf16 v[16:31], a[28:31], v[60:63], v[16:31]
  ds_read_b128 v[56:59], v3 offset:10240
  s_add_u32 s95, s77, s13
  buffer_load_dwordx4 v[96:99], v2, s[4:7], s95 offen offset:0 sc1
  s_waitcnt lgkmcnt(1)
  v_mfma_f32_32x32x16_bf16 v[16:31], a[32:35], v[48:51], v[16:31]
  ds_read_b128 v[60:63], v3 offset:11264
  v_mfma_f32_32x32x16_bf16 v[16:31], a[36:39], v[52:55], v[16:31]
  ds_read_b128 v[48:51], v3 offset:12288
  s_add_u32 s95, s77, s13
  buffer_load_dwordx4 v[100:103], v2, s[4:7], s95 offen offset:1024 sc1
  s_waitcnt lgkmcnt(1)
  v_mfma_f32_32x32x16_bf16 v[16:31], a[40:43], v[56:59], v[16:31]
  ds_read_b128 v[52:55], v3 offset:13312
  v_mfma_f32_32x32x16_bf16 v[16:31], a[44:47], v[60:63], v[16:31]
  ds_read_b128 v[56:59], v3 offset:14336
  s_add_u32 s95, s77, s13
  buffer_load_dwordx4 v[104:107], v2, s[4:7], s95 offen offset:2048 sc1
  s_waitcnt lgkmcnt(1)
  v_mfma_f32_32x32x16_bf16 v[16:31], a[48:51], v[48:51], v[16:31]
  ds_read_b128 v[60:63], v3 offset:15360
  v_mfma_f32_32x32x16_bf16 v[16:31], a[52:55], v[52:55], v[16:31]
  ds_read_b128 v[48:51], v3 offset:16384
  s_add_u32 s95, s77, s13
  buffer_load_dwordx4 v[108:111], v2, s[4:7], s95 offen offset:3072 sc1
  s_waitcnt lgkmcnt(1)
  v_mfma_f32_32x32x16_bf16 v[16:31], a[56:59], v[56:59], v[16:31]
  ds_read_b128 v[52:55], v3 offset:17408
  s_add_u32 s95, s77, s14
  buffer_load_dwordx4 v[112:115], v2, s[4:7], s95 offen offset:0 sc1
  v_mfma_f32_32x32x16_bf16 v[16:31], a[60:63], v[60:63], v[16:31]
  ds_read_b128 v[56:59], v3 offset:18432
  s_waitcnt lgkmcnt(1)
  v_mfma_f32_32x32x16_bf16 v[16:31], a[64:67], v[48:51], v[16:31]
  ds_read_b128 v[60:63], v3 offset:19456
  s_add_u32 s95, s77, s14
  buffer_load_dwordx4 v[116:119], v2, s[4:7], s95 offen offset:1024 sc1
  v_mfma_f32_32x32x16_bf16 v[16:31], a[68:71], v[52:55], v[16:31]
  ds_read_b128 v[48:51], v3 offset:20480
  s_waitcnt lgkmcnt(1)
  v_mfma_f32_32x32x16_bf16 v[16:31], a[72:75], v[56:59], v[16:31]
  ds_read_b128 v[52:55], v3 offset:21504
  s_add_u32 s95, s77, s14
  buffer_load_dwordx4 v[120:123], v2, s[4:7], s95 offen offset:2048 sc1
  s_waitcnt vmcnt(22)
  v_mfma_f32_32x32x16_bf16 v[16:31], a[76:79], v[60:63], v[16:31]
  ds_read_b128 v[56:59], v3 offset:22528
  s_waitcnt lgkmcnt(1)
  s_waitcnt vmcnt(21)
  v_mfma_f32_32x32x16_bf16 v[16:31], a[80:83], v[48:51], v[16:31]
  ds_read_b128 v[60:63], v3 offset:23552
  s_add_u32 s95, s77, s14
  buffer_load_dwordx4 v[124:127], v2, s[4:7], s95 offen offset:3072 sc1
  s_waitcnt vmcnt(21)
  v_mfma_f32_32x32x16_bf16 v[16:31], a[84:87], v[52:55], v[16:31]
  ds_read_b128 v[48:51], v3 offset:24576
  s_waitcnt lgkmcnt(1)
  s_waitcnt vmcnt(20)
  v_mfma_f32_32x32x16_bf16 v[16:31], a[88:91], v[56:59], v[16:31]
  ds_read_b128 v[52:55], v3 offset:25600
  s_add_u32 s95, s77, s15
  buffer_load_dwordx4 v[128:131], v2, s[4:7], s95 offen offset:0 sc1
  s_waitcnt vmcnt(20)
  v_mfma_f32_32x32x16_bf16 v[16:31], a[92:95], v[60:63], v[16:31]
  ds_read_b128 v[56:59], v3 offset:26624
  s_add_u32 s95, s77, s15
  buffer_load_dwordx4 v[132:135], v2, s[4:7], s95 offen offset:1024 sc1
  s_waitcnt lgkmcnt(1)
  s_waitcnt vmcnt(20)
  v_mfma_f32_32x32x16_bf16 v[16:31], a[96:99], v[48:51], v[16:31]
  ds_read_b128 v[60:63], v3 offset:27648
  s_waitcnt vmcnt(19)
  v_mfma_f32_32x32x16_bf16 v[16:31], a[100:103], v[52:55], v[16:31]
  v_mov_b32 v10, 163328
  s_mov_b32 s96, 400000
LB_43:
  ds_read_b32 v11, v10 offset:44
  s_waitcnt lgkmcnt(0)
  v_readfirstlane_b32 s55, v11
  s_nop 0
  s_cmp_ge_u32 s55, 1
  s_cbranch_scc1 LBD_44
  s_sub_u32 s96, s96, 1
  s_cmp_lg_u32 s96, 0
  s_cbranch_scc1 LB_43
  s_or_b32 s97, s97, 4096
LBD_44:
  ds_read_b128 v[68:71], v4 offset:0
  s_waitcnt vmcnt(18)
  v_mfma_f32_32x32x16_bf16 v[16:31], a[104:107], v[56:59], v[16:31]
  s_waitcnt vmcnt(17)
  v_mfma_f32_32x32x16_bf16 v[16:31], a[108:111], v[60:63], v[16:31]
  s_waitcnt lgkmcnt(0)
  v_accvgpr_write_b32 a116, v71
  v_accvgpr_write_b32 a117, v71
  v_accvgpr_write_b32 a118, v71
  v_accvgpr_write_b32 a119, v71
  s_waitcnt vmcnt(14)
  s_nop 0
  v_mfma_f32_32x32x16_bf16 v[16:31], a[112:115], a[116:119], v[16:31]
  s_waitcnt lgkmcnt(0)
  v_mov_b32 v10, 163328
  v_mov_b32 v11, 1
  s_mov_b64 exec, 1
  ds_add_rtn_u32 v11, v10, v11 offset:52
  s_mov_b64 exec, -1
  s_waitcnt lgkmcnt(0)
  v_readfirstlane_b32 s55, v11
  s_nop 0
  s_cmp_eq_u32 s55, 3
  s_cselect_b64 exec, s[84:85], 0
  buffer_store_dwordx2 v[8:9], v7, s[4:7], 0 offen offset:640 sc1
  s_mov_b64 exec, -1
  s_setprio 1
  v_mul_f32 v64, v16, v16
  v_mul_f32 v65, v17, v17
  v_mul_f32 v66, v18, v18
  v_mul_f32 v67, v19, v19
  v_fma_f32 v64, v64, v70, v69
  v_fma_f32 v65, v65, v70, v69
  v_fma_f32 v66, v66, v70, v69
  v_fma_f32 v67, v67, v70, v69
  v_mul_f32 v64, v64, v16
  v_mul_f32 v65, v65, v17
  v_mul_f32 v66, v66, v18
  v_mul_f32 v67, v67, v19
  v_exp_f32 v64, v64
  v_exp_f32 v65, v65
  v_exp_f32 v66, v66
  v_exp_f32 v67, v67
  v_fma_f32 v64, v64, v68, v68
  v_fma_f32 v65, v65, v68, v68
  v_fma_f32 v66, v66, v68, v68
  v_fma_f32 v67, v67, v68, v68
  v_rcp_f32 v64, v64
  v_rcp_f32 v65, v65
  v_rcp_f32 v66, v66
  v_rcp_f32 v67, v67
  v_mul_f32 v64, v64, v16
  v_mul_f32 v65, v65, v17
  v_mul_f32 v66, v66, v18
  v_mul_f32 v67, v67, v19
  v_cvt_pk_bf16_f32 v72, v64, v65
  v_cvt_pk_bf16_f32 v73, v66, v67
  v_mul_f32 v64, v20, v20
  v_mul_f32 v65, v21, v21
  v_mul_f32 v66, v22, v22
  v_mul_f32 v67, v23, v23
  v_fma_f32 v64, v64, v70, v69
  v_fma_f32 v65, v65, v70, v69
  v_fma_f32 v66, v66, v70, v69
  v_fma_f32 v67, v67, v70, v69
  v_mul_f32 v64, v64, v20
  v_mul_f32 v65, v65, v21
  v_mul_f32 v66, v66, v22
  v_mul_f32 v67, v67, v23
  v_exp_f32 v64, v64
  v_exp_f32 v65, v65
  v_exp_f32 v66, v66
  v_exp_f32 v67, v67
  v_fma_f32 v64, v64, v68, v68
  v_fma_f32 v65, v65, v68, v68
  v_fma_f32 v66, v66, v68, v68
  v_fma_f32 v67, v67, v68, v68
  v_rcp_f32 v64, v64
  v_rcp_f32 v65, v65
  v_rcp_f32 v66, v66
  v_rcp_f32 v67, v67
  v_mul_f32 v64, v64, v20
  v_mul_f32 v65, v65, v21
  v_mul_f32 v66, v66, v22
  v_mul_f32 v67, v67, v23
  v_cvt_pk_bf16_f32 v74, v64, v65
  v_cvt_pk_bf16_f32 v75, v66, v67
  buffer_store_dwordx4 v[72:75], v1, s[4:7], s80 offen offset:0 sc1
  v_mul_f32 v64, v24, v24
  v_mul_f32 v65, v25, v25
  v_mul_f32 v66, v26, v26
  v_mul_f32 v67, v27, v27
  v_fma_f32 v64, v64, v70, v69
  v_fma_f32 v65, v65, v70, v69
  v_fma_f32 v66, v66, v70, v69
  v_fma_f32 v67, v67, v70, v69
  v_mul_f32 v64, v64, v24
  v_mul_f32 v65, v65, v25
  v_mul_f32 v66, v66, v26
  v_mul_f32 v67, v67, v27
  v_exp_f32 v64, v64
  v_exp_f32 v65, v65
  v_exp_f32 v66, v66
  v_exp_f32 v67, v67
  v_fma_f32 v64, v64, v68, v68
  v_fma_f32 v65, v65, v68, v68
  v_fma_f32 v66, v66, v68, v68
  v_fma_f32 v67, v67, v68, v68
  v_rcp_f32 v64, v64
  v_rcp_f32 v65, v65
  v_rcp_f32 v66, v66
  v_rcp_f32 v67, v67
  v_mul_f32 v64, v64, v24
  v_mul_f32 v65, v65, v25
  v_mul_f32 v66, v66, v26
  v_mul_f32 v67, v67, v27
  v_cvt_pk_bf16_f32 v76, v64, v65
  v_cvt_pk_bf16_f32 v77, v66, v67
  v_mul_f32 v64, v28, v28
  v_mul_f32 v65, v29, v29
  v_mul_f32 v66, v30, v30
  v_mul_f32 v67, v31, v31
  v_fma_f32 v64, v64, v70, v69
  v_fma_f32 v65, v65, v70, v69
  v_fma_f32 v66, v66, v70, v69
  v_fma_f32 v67, v67, v70, v69
  v_mul_f32 v64, v64, v28
  v_mul_f32 v65, v65, v29
  v_mul_f32 v66, v66, v30
  v_mul_f32 v67, v67, v31
  v_exp_f32 v64, v64
  v_exp_f32 v65, v65
  v_exp_f32 v66, v66
  v_exp_f32 v67, v67
  v_fma_f32 v64, v64, v68, v68
  v_fma_f32 v65, v65, v68, v68
  v_fma_f32 v66, v66, v68, v68
  v_fma_f32 v67, v67, v68, v68
  v_rcp_f32 v64, v64
  v_rcp_f32 v65, v65
  v_rcp_f32 v66, v66
  v_rcp_f32 v67, v67
  v_mul_f32 v64, v64, v28
  v_mul_f32 v65, v65, v29
  v_mul_f32 v66, v66, v30
  v_mul_f32 v67, v67, v31
  v_cvt_pk_bf16_f32 v78, v64, v65
  v_cvt_pk_bf16_f32 v79, v66, v67
  buffer_store_dwordx4 v[76:79], v1, s[4:7], s80 offen offset:2048 sc1
  s_lshl_b32 s55, s91, 11
  s_add_u32 s55, s55, 131072 + 2048
  v_add_u32 v13, s55, v2
  ds_write_b128 v13, v[72:75]
  ds_write_b128 v13, v[76:79] offset:1024
  ds_read_b128 v[68:71], v4 offset:512
  s_setprio 1
  ds_read_b128 v[48:51], v3 offset:28672
  ds_read_b128 v[52:55], v3 offset:29696
  ds_read_b128 v[56:59], v3 offset:30720
  s_waitcnt lgkmcnt(1)
  v_mfma_f32_32x32x16_bf16 v[32:47], a[0:3], v[48:51], 0
  ds_read_b128 v[60:63], v3 offset:31744
  v_mfma_f32_32x32x16_bf16 v[32:47], a[4:7], v[52:55], v[32:47]
  ds_read_b128 v[48:51], v3 offset:32768
  s_waitcnt lgkmcnt(1)
  v_mfma_f32_32x32x16_bf16 v[32:47], a[8:11], v[56:59], v[32:47]
  ds_read_b128 v[52:55], v3 offset:33792
  v_mfma_f32_32x32x16_bf16 v[32:47], a[12:15], v[60:63], v[32:47]
  ds_read_b128 v[56:59], v3 offset:34816
  s_add_u32 s95, s77, s15
  buffer_load_dwordx4 a[0:3], v2, s[4:7], s95 offen offset:2048 sc1
  s_waitcnt lgkmcnt(1)
  v_mfma_f32_32x32x16_bf16 v[32:47], a[16:19], v[48:51], v[32:47]
  ds_read_b128 v[60:63], v3 offset:35840
  v_mfma_f32_32x32x16_bf16 v[32:47], a[20:23], v[52:55], v[32:47]
  ds_read_b128 v[48:51], v3 offset:36864
  s_waitcnt lgkmcnt(1)
  v_mfma_f32_32x32x16_bf16 v[32:47], a[24:27], v[56:59], v[32:47]
  ds_read_b128 v[52:55], v3 offset:37888
  s_add_u32 s95, s77, s15
  buffer_load_dwordx4 a[4:7], v2, s[4:7], s95 offen offset:3072 sc1
  v_accvgpr_write_b32 a116, v71
  v_accvgpr_write_b32 a117, v71
  v_accvgpr_write_b32 a118, v71
  v_accvgpr_write_b32 a119, v71
  v_mfma_f32_32x32x16_bf16 v[32:47], a[28:31], v[60:63], v[32:47]
  ds_read_b128 v[56:59], v3 offset:38912
  s_waitcnt lgkmcnt(1)
  v_mfma_f32_32x32x16_bf16 v[32:47], a[32:35], v[48:51], v[32:47]
  ds_read_b128 v[60:63], v3 offset:39936
  v_mfma_f32_32x32x16_bf16 v[32:47], a[36:39], v[52:55], v[32:47]
  ds_read_b128 v[48:51], v3 offset:40960
  s_add_u32 s95, s77, s81
  buffer_load_dwordx4 a[8:11], v2, s[4:7], s95 offen offset:0 sc1
  s_waitcnt lgkmcnt(1)
  v_mfma_f32_32x32x16_bf16 v[32:47], a[40:43], v[56:59], v[32:47]
  ds_read_b128 v[52:55], v3 offset:41984
  v_mfma_f32_32x32x16_bf16 v[32:47], a[44:47], v[60:63], v[32:47]
  ds_read_b128 v[56:59], v3 offset:43008
  s_waitcnt lgkmcnt(1)
  v_mfma_f32_32x32x16_bf16 v[32:47], a[48:51], v[48:51], v[32:47]
  ds_read_b128 v[60:63], v3 offset:44032
  s_add_u32 s95, s77, s81
  buffer_load_dwordx4 a[12:15], v2, s[4:7], s95 offen offset:1024 sc1
  v_mfma_f32_32x32x16_bf16 v[32:47], a[52:55], v[52:55], v[32:47]
  ds_read_b128 v[48:51], v3 offset:45056
  s_waitcnt lgkmcnt(1)
  v_mfma_f32_32x32x16_bf16 v[32:47], a[56:59], v[56:59], v[32:47]
  ds_read_b128 v[52:55], v3 offset:46080
  v_mfma_f32_32x32x16_bf16 v[32:47], a[60:63], v[60:63], v[32:47]
  ds_read_b128 v[56:59], v3 offset:47104
  s_add_u32 s95, s77, s81
  buffer_load_dwordx4 a[16:19], v2, s[4:7], s95 offen offset:2048 sc1
  s_waitcnt lgkmcnt(1)
  v_mfma_f32_32x32x16_bf16 v[32:47], a[64:67], v[48:51], v[32:47]
  ds_read_b128 v[60:63], v3 offset:48128
  v_mfma_f32_32x32x16_bf16 v[32:47], a[68:71], v[52:55], v[32:47]
  ds_read_b128 v[48:51], v3 offset:49152
  s_waitcnt lgkmcnt(1)
  v_mfma_f32_32x32x16_bf16 v[32:47], a[72:75], v[56:59], v[32:47]
  ds_read_b128 v[52:55], v3 offset:50176
  s_add_u32 s95, s77, s81
  buffer_load_dwordx4 a[20:23], v2, s[4:7], s95 offen offset:3072 sc1
  v_mfma_f32_32x32x16_bf16 v[32:47], a[76:79], v[60:63], v[32:47]
  ds_read_b128 v[56:59], v3 offset:51200
  s_waitcnt lgkmcnt(1)
  v_mfma_f32_32x32x16_bf16 v[32:47], a[80:83], v[48:51], v[32:47]
  ds_read_b128 v[60:63], v3 offset:52224
  s_waitcnt vmcnt(6)
  s_mov_b64 exec, 0x7f
  buffer_store_dwordx2 v[8:9], v5, s[4:7], 0 offen offset:2048 sc1
  s_mov_b64 exec, -1
  v_mfma_f32_32x32x16_bf16 v[32:47], a[84:87], v[52:55], v[32:47]
  ds_read_b128 v[48:51], v3 offset:53248
  s_add_u32 s95, s77, s82
  buffer_load_dwordx4 a[24:27], v2, s[4:7], s95 offen offset:0 sc1
  s_waitcnt lgkmcnt(1)
  v_mfma_f32_32x32x16_bf16 v[32:47], a[88:91], v[56:59], v[32:47]
  ds_read_b128 v[52:55], v3 offset:54272
  v_mfma_f32_32x32x16_bf16 v[32:47], a[92:95], v[60:63], v[32:47]
  ds_read_b128 v[56:59], v3 offset:55296
  s_waitcnt lgkmcnt(1)
  v_mfma_f32_32x32x16_bf16 v[32:47], a[96:99], v[48:51], v[32:47]
  ds_read_b128 v[60:63], v3 offset:56320
  s_add_u32 s95, s77, s82
  buffer_load_dwordx4 a[28:31], v2, s[4:7], s95 offen offset:1024 sc1
  v_mfma_f32_32x32x16_bf16 v[32:47], a[100:103], v[52:55], v[32:47]
  s_waitcnt lgkmcnt(0)
  v_mfma_f32_32x32x16_bf16 v[32:47], a[104:107], v[56:59], v[32:47]
  v_mfma_f32_32x32x16_bf16 v[32:47], a[108:111], v[60:63], v[32:47]
  s_add_u32 s95, s77, s82
  buffer_load_dwordx4 a[32:35], v2, s[4:7], s95 offen offset:2048 sc1
  v_mfma_f32_32x32x16_bf16 v[32:47], a[112:115], a[116:119], v[32:47]
  s_setprio 1
  v_and_b32 v48, 31, v0
  v_lshrrev_b32 v49, 5, v0
  v_mul_u32_u24 v49, 28672, v49
  v_lshl_add_u32 v49, v48, 4, v49
  s_lshl_b32 s55, s51, 12
  s_lshl_b32 s56, s91, 9
  s_add_u32 s55, s55, s56
  s_add_u32 s55, s55, 47104
  v_add_u32 v49, s55, v49
  s_nop 1
  v_pk_mul_f32 v[52:53], v[32:33], v[32:33]
  v_pk_mul_f32 v[54:55], v[34:35], v[34:35]
  v_pk_mul_f32 v[56:57], v[36:37], v[36:37]
  v_pk_mul_f32 v[58:59], v[38:39], v[38:39]
  v_pk_mul_f32 v[60:61], v[40:41], v[40:41]
  v_pk_mul_f32 v[62:63], v[42:43], v[42:43]
  v_pk_mul_f32 v[64:65], v[44:45], v[44:45]
  v_pk_mul_f32 v[66:67], v[46:47], v[46:47]
  v_pk_fma_f32 v[52:53], v[52:53], v[70:71], v[68:69] op_sel:[0,0,1] op_sel_hi:[1,0,1]
  v_pk_fma_f32 v[54:55], v[54:55], v[70:71], v[68:69] op_sel:[0,0,1] op_sel_hi:[1,0,1]
  v_pk_fma_f32 v[56:57], v[56:57], v[70:71], v[68:69] op_sel:[0,0,1] op_sel_hi:[1,0,1]
  v_pk_fma_f32 v[58:59], v[58:59], v[70:71], v[68:69] op_sel:[0,0,1] op_sel_hi:[1,0,1]
  ds_read_b128 a[112:115], v49
  v_mov_b32 v51, 1
  v_mov_b32 v50, 163328
  s_mov_b64 exec, 1
  ds_add_u32 v50, v51 offset:40
  s_mov_b64 exec, -1
  v_pk_fma_f32 v[60:61], v[60:61], v[70:71], v[68:69] op_sel:[0,0,1] op_sel_hi:[1,0,1]
  v_pk_fma_f32 v[62:63], v[62:63], v[70:71], v[68:69] op_sel:[0,0,1] op_sel_hi:[1,0,1]
  v_pk_fma_f32 v[64:65], v[64:65], v[70:71], v[68:69] op_sel:[0,0,1] op_sel_hi:[1,0,1]
  v_pk_fma_f32 v[66:67], v[66:67], v[70:71], v[68:69] op_sel:[0,0,1] op_sel_hi:[1,0,1]
  v_pk_mul_f32 v[52:53], v[52:53], v[32:33]
  v_pk_mul_f32 v[54:55], v[54:55], v[34:35]
  v_pk_mul_f32 v[56:57], v[56:57], v[36:37]
  v_pk_mul_f32 v[58:59], v[58:59], v[38:39]
  v_pk_mul_f32 v[60:61], v[60:61], v[40:41]
  v_pk_mul_f32 v[62:63], v[62:63], v[42:43]
  v_pk_mul_f32 v[64:65], v[64:65], v[44:45]
  v_pk_mul_f32 v[66:67], v[66:67], v[46:47]
  v_exp_f32 v52, v52
  v_exp_f32 v53, v53
  v_exp_f32 v54, v54
  v_exp_f32 v55, v55
  v_exp_f32 v56, v56
  v_exp_f32 v57, v57
  v_exp_f32 v58, v58
  v_exp_f32 v59, v59
  v_exp_f32 v60, v60
  v_exp_f32 v61, v61
  v_exp_f32 v62, v62
  v_exp_f32 v63, v63
  v_exp_f32 v64, v64
  v_exp_f32 v65, v65
  v_exp_f32 v66, v66
  v_exp_f32 v67, v67
  v_pk_fma_f32 v[52:53], v[52:53], v[68:69], v[68:69] op_sel_hi:[1,0,0]
  v_pk_fma_f32 v[54:55], v[54:55], v[68:69], v[68:69] op_sel_hi:[1,0,0]
  v_pk_fma_f32 v[56:57], v[56:57], v[68:69], v[68:69] op_sel_hi:[1,0,0]
  v_pk_fma_f32 v[58:59], v[58:59], v[68:69], v[68:69] op_sel_hi:[1,0,0]
  v_pk_fma_f32 v[60:61], v[60:61], v[68:69], v[68:69] op_sel_hi:[1,0,0]
  v_pk_fma_f32 v[62:63], v[62:63], v[68:69], v[68:69] op_sel_hi:[1,0,0]
  v_pk_fma_f32 v[64:65], v[64:65], v[68:69], v[68:69] op_sel_hi:[1,0,0]
  v_pk_fma_f32 v[66:67], v[66:67], v[68:69], v[68:69] op_sel_hi:[1,0,0]
  v_rcp_f32 v52, v52
  v_rcp_f32 v53, v53
  v_rcp_f32 v54, v54
  v_rcp_f32 v55, v55
  v_rcp_f32 v56, v56
  v_rcp_f32 v57, v57
  v_rcp_f32 v58, v58
  v_rcp_f32 v59, v59
  v_rcp_f32 v60, v60
  v_rcp_f32 v61, v61
  v_rcp_f32 v62, v62
  v_rcp_f32 v63, v63
  v_rcp_f32 v64, v64
  s_load_dwordx16 s[16:31], s[46:47], s62 glc
  v_rcp_f32 v65, v65
  v_rcp_f32 v66, v66
  v_rcp_f32 v67, v67
  v_pk_mul_f32 v[52:53], v[52:53], v[32:33]
  v_pk_mul_f32 v[54:55], v[54:55], v[34:35]
  v_pk_mul_f32 v[56:57], v[56:57], v[36:37]
  v_pk_mul_f32 v[58:59], v[58:59], v[38:39]
  v_pk_mul_f32 v[60:61], v[60:61], v[40:41]
  v_pk_mul_f32 v[62:63], v[62:63], v[42:43]
  v_pk_mul_f32 v[64:65], v[64:65], v[44:45]
  v_pk_mul_f32 v[66:67], v[66:67], v[46:47]
  v_cvt_pk_bf16_f32 v72, v52, v53
  v_cvt_pk_bf16_f32 v73, v54, v55
  v_cvt_pk_bf16_f32 v74, v56, v57
  v_cvt_pk_bf16_f32 v75, v58, v59
  buffer_store_dwordx4 v[72:75], v1, s[4:7], s80 offen offset:512 sc1
  v_cvt_pk_bf16_f32 v76, v60, v61
  v_cvt_pk_bf16_f32 v77, v62, v63
  v_cvt_pk_bf16_f32 v78, v64, v65
  v_cvt_pk_bf16_f32 v79, v66, v67
  buffer_store_dwordx4 v[76:79], v1, s[4:7], s80 offen offset:2560 sc1
  s_setprio 0
  s_lshl_b32 s55, s50, 6
  v_add_u32 v14, s55, v0
  v_mul_u32_u24 v14, 896, v14
  s_lshl_b32 s55, s51, 7
  s_lshl_b32 s56, s91, 4
  s_add_u32 s55, s55, s56
  v_add_u32 v14, s55, v14
  v_lshrrev_b32 v49, 5, v0
  v_lshlrev_b32 v15, 11, v49
  v_lshl_add_u32 v15, v48, 4, v15
  s_lshl_b32 s55, s91, 14
  v_add_u32 v15, s55, v15
  s_lshl_b32 s55, s91, 11
  v_add_u32 v4, s55, v2
  v_bfe_u32 v3, v0, 2, 2
  v_lshlrev_b32 v3, 7, v3
  v_lshrrev_b32 v49, 4, v0
  v_lshl_add_u32 v3, v49, 5, v3
  v_and_b32 v49, 3, v0
  v_lshl_add_u32 v3, v49, 3, v3
  s_lshl_b32 s65, s91, 10
  s_add_u32 s65, s65, 153600
  v_add_u32 v3, s65, v3
  s_lshl_b32 s55, s51, 6
  s_lshl_b32 s56, s91, 3
  s_add_u32 s55, s55, s56
  s_mul_i32 s55, s55, 4224
  s_lshl_b32 s56, s50, 6
  s_add_u32 s55, s55, s56
  s_add_u32 s64, s55, 9437184
  ds_read_b128 a[56:59], v13
  ds_read_b128 a[60:63], v13 offset:1024
  v_accvgpr_write_b32 a80, v72
  v_accvgpr_write_b32 a81, v73
  v_accvgpr_write_b32 a82, v74
  v_accvgpr_write_b32 a83, v75
  v_accvgpr_write_b32 a84, v76
  v_accvgpr_write_b32 a85, v77
  v_accvgpr_write_b32 a86, v78
  v_accvgpr_write_b32 a87, v79
  s_mov_b32 s61, 0
  s_waitcnt lgkmcnt(0)
  s_cmp_lg_u64 s[16:17], s[48:49]
  s_cselect_b32 s95, 1, 0
  s_cmp_lg_u64 s[18:19], s[48:49]
  s_addc_u32 s95, s95, 0
  s_cmp_lg_u64 s[20:21], s[48:49]
  s_addc_u32 s95, s95, 0
  s_cmp_lg_u64 s[22:23], s[48:49]
  s_addc_u32 s95, s95, 0
  s_cmp_lg_u64 s[24:25], s[48:49]
  s_addc_u32 s95, s95, 0
  s_cmp_lg_u64 s[26:27], s[48:49]
  s_addc_u32 s95, s95, 0
  s_cmp_lg_u64 s[28:29], s[48:49]
  s_addc_u32 s95, s95, 0
  s_cmp_eq_u32 s95, 0
  s_cbranch_scc0 SSLOW_45
SBACK_46:
  s_add_u32 s95, s83, s13
  buffer_load_dwordx4 a[64:67], v1, s[4:7], s95 offen offset:0 sc1
  s_add_u32 s95, s83, s13
  buffer_load_dwordx4 a[68:71], v1, s[4:7], s95 offen offset:2048 sc1
  s_add_u32 s95, s83, s14
  buffer_load_dwordx4 a[72:75], v1, s[4:7], s95 offen offset:0 sc1
  s_add_u32 s95, s83, s14
  buffer_load_dwordx4 a[76:79], v1, s[4:7], s95 offen offset:2048 sc1
  s_add_u32 s95, s83, s15
  buffer_load_dwordx4 v[48:51], v1, s[4:7], s95 offen offset:0 sc1
  s_add_u32 s95, s83, s15
  buffer_load_dwordx4 v[52:55], v1, s[4:7], s95 offen offset:2048 sc1
  s_add_u32 s95, s83, s81
  buffer_load_dwordx4 v[56:59], v1, s[4:7], s95 offen offset:0 sc1
  s_cmp_eq_u32 s61, 1
  s_cbranch_scc1 SG_47
  s_waitcnt vmcnt(7)
  s_mov_b64 exec, 0x7f
  buffer_store_dwordx2 v[8:9], v5, s[4:7], 0 offen offset:2560 sc1
  s_mov_b64 exec, -1
SG_47:
  v_mov_b32 v10, 0
  s_or_b32 s55, s2, s91
  s_cmp_eq_u32 s55, 0
  s_cselect_b64 exec, 1, 0
  buffer_store_dwordx2 v[8:9], v10, s[4:7], 0 offen sc1
  s_mov_b64 exec, -1
  v_mfma_f32_32x32x16_bf16 v[16:31], v[80:83], a[56:59], 0
  v_mfma_f32_32x32x16_bf16 v[32:47], v[84:87], a[56:59], 0
  s_add_u32 s95, s83, s81
  buffer_load_dwordx4 v[60:63], v1, s[4:7], s95 offen offset:2048 sc1
  s_add_u32 s95, s77, s82
  buffer_load_dwordx4 a[36:39], v2, s[4:7], s95 offen offset:3072 sc1
  s_add_u32 s95, s77, s3
  buffer_load_dwordx4 a[40:43], v2, s[4:7], s95 offen offset:0 sc1
  v_mfma_f32_32x32x16_bf16 v[16:31], v[88:91], a[60:63], v[16:31]
  v_mfma_f32_32x32x16_bf16 v[32:47], v[92:95], a[60:63], v[32:47]
  s_add_u32 s95, s83, s82
  buffer_load_dwordx4 v[64:67], v1, s[4:7], s95 offen offset:0 sc1
  s_add_u32 s95, s77, s3
  buffer_load_dwordx4 a[44:47], v2, s[4:7], s95 offen offset:1024 sc1
  s_add_u32 s95, s77, s3
  buffer_load_dwordx4 a[48:51], v2, s[4:7], s95 offen offset:2048 sc1
  s_waitcnt vmcnt(12)
  v_mfma_f32_32x32x16_bf16 v[16:31], v[96:99], a[64:67], v[16:31]
  v_mfma_f32_32x32x16_bf16 v[32:47], v[100:103], a[64:67], v[32:47]
  s_add_u32 s95, s83, s82
  buffer_load_dwordx4 v[68:71], v1, s[4:7], s95 offen offset:2048 sc1
  s_add_u32 s95, s77, s3
  buffer_load_dwordx4 a[52:55], v2, s[4:7], s95 offen offset:3072 sc1
  s_add_u32 s95, s83, s3
  buffer_load_dwordx4 v[72:75], v1, s[4:7], s95 offen offset:0 sc1
  s_waitcnt vmcnt(14)
  v_mfma_f32_32x32x16_bf16 v[16:31], v[104:107], a[68:71], v[16:31]
  v_mfma_f32_32x32x16_bf16 v[32:47], v[108:111], a[68:71], v[32:47]
  s_add_u32 s95, s83, s3
  buffer_load_dwordx4 v[76:79], v1, s[4:7], s95 offen offset:2048 sc1
  s_waitcnt vmcnt(14)
  v_mfma_f32_32x32x16_bf16 v[16:31], v[112:115], a[72:75], v[16:31]
  v_mfma_f32_32x32x16_bf16 v[32:47], v[116:119], a[72:75], v[32:47]
  s_waitcnt vmcnt(13)
  v_mfma_f32_32x32x16_bf16 v[16:31], v[120:123], a[76:79], v[16:31]
  v_mfma_f32_32x32x16_bf16 v[32:47], v[124:127], a[76:79], v[32:47]
  s_mov_b64 exec, s[84:85]
  buffer_load_dwordx2 v[10:11], v6, s[4:7], 0 offen offset:640 sc1
  s_mov_b64 exec, -1
  s_add_u32 s95, s62, 512
  s_load_dwordx16 s[16:31], s[46:47], s95 glc
  s_waitcnt vmcnt(13)
  v_mfma_f32_32x32x16_bf16 v[16:31], v[128:131], v[48:51], v[16:31]
  v_mfma_f32_32x32x16_bf16 v[32:47], v[132:135], v[48:51], v[32:47]
  s_waitcnt vmcnt(12)
  v_mfma_f32_32x32x16_bf16 v[16:31], a[0:3], v[52:55], v[16:31]
  v_mfma_f32_32x32x16_bf16 v[32:47], a[4:7], v[52:55], v[32:47]
  s_waitcnt vmcnt(11)
  v_mfma_f32_32x32x16_bf16 v[16:31], a[8:11], v[56:59], v[16:31]
  v_mfma_f32_32x32x16_bf16 v[32:47], a[12:15], v[56:59], v[32:47]
  s_waitcnt lgkmcnt(0)
  s_cmp_lg_u64 s[16:17], s[48:49]
  s_cselect_b32 s95, 1, 0
  s_cmp_lg_u64 s[18:19], s[48:49]
  s_addc_u32 s95, s95, 0
  s_cmp_lg_u64 s[20:21], s[48:49]
  s_addc_u32 s95, s95, 0
  s_cmp_lg_u64 s[22:23], s[48:49]
  s_addc_u32 s95, s95, 0
  s_cmp_lg_u64 s[24:25], s[48:49]
  s_addc_u32 s95, s95, 0
  s_cmp_lg_u64 s[26:27], s[48:49]
  s_addc_u32 s95, s95, 0
  s_cmp_lg_u64 s[28:29], s[48:49]
  s_addc_u32 s95, s95, 0
  s_cmp_eq_u32 s95, 0
  s_cbranch_scc0 SSLOW_48
SBACK_49:
  s_add_u32 s95, s83, s13
  buffer_load_dwordx4 a[88:91], v1, s[4:7], s95 offen offset:512 sc1
  s_add_u32 s95, s83, s13
  buffer_load_dwordx4 a[92:95], v1, s[4:7], s95 offen offset:2560 sc1
  s_add_u32 s95, s83, s14
  buffer_load_dwordx4 a[96:99], v1, s[4:7], s95 offen offset:512 sc1
  s_add_u32 s95, s83, s14
  buffer_load_dwordx4 a[100:103], v1, s[4:7], s95 offen offset:2560 sc1
  s_waitcnt vmcnt(14)
  v_mfma_f32_32x32x16_bf16 v[16:31], a[16:19], v[60:63], v[16:31]
  v_mfma_f32_32x32x16_bf16 v[32:47], a[20:23], v[60:63], v[32:47]
  s_add_u32 s95, s83, s15
  buffer_load_dwordx4 a[104:107], v1, s[4:7], s95 offen offset:512 sc1
  s_add_u32 s95, s83, s15
  buffer_load_dwordx4 a[108:111], v1, s[4:7], s95 offen offset:2560 sc1
  s_add_u32 s95, s83, s81
  buffer_load_dwordx4 a[56:59], v1, s[4:7], s95 offen offset:512 sc1
  s_add_u32 s95, s83, s81
  buffer_load_dwordx4 a[60:63], v1, s[4:7], s95 offen offset:2560 sc1
  s_waitcnt vmcnt(15)
  v_mfma_f32_32x32x16_bf16 v[16:31], a[24:27], v[64:67], v[16:31]
  v_mfma_f32_32x32x16_bf16 v[32:47], a[28:31], v[64:67], v[32:47]
  s_add_u32 s95, s83, s82
  buffer_load_dwordx4 a[64:67], v1, s[4:7], s95 offen offset:512 sc1
  s_add_u32 s95, s83, s82
  buffer_load_dwordx4 a[68:71], v1, s[4:7], s95 offen offset:2560 sc1
  s_add_u32 s95, s83, s3
  buffer_load_dwordx4 a[72:75], v1, s[4:7], s95 offen offset:512 sc1
  s_add_u32 s95, s83, s3
  buffer_load_dwordx4 a[76:79], v1, s[4:7], s95 offen offset:2560 sc1
  s_waitcnt vmcnt(16)
  v_mfma_f32_32x32x16_bf16 v[16:31], a[32:35], v[68:71], v[16:31]
  v_mfma_f32_32x32x16_bf16 v[32:47], a[36:39], v[68:71], v[32:47]
  s_waitcnt vmcnt(14)
  v_mfma_f32_32x32x16_bf16 v[16:31], a[40:43], v[72:75], v[16:31]
  v_mfma_f32_32x32x16_bf16 v[32:47], a[44:47], v[72:75], v[32:47]
  s_waitcnt vmcnt(13)
  v_mfma_f32_32x32x16_bf16 v[16:31], a[48:51], v[76:79], v[16:31]
  v_mfma_f32_32x32x16_bf16 v[32:47], a[52:55], v[76:79], v[32:47]
  s_waitcnt vmcnt(12)
  s_mov_b64 exec, s[84:85]
  v_cmp_ne_u64 vcc, v[10:11], v[8:9]
  s_cbranch_vccnz PSLOW_50
PBACK_51:
  s_mov_b64 exec, -1
  v_lshrrev_b32 v10, 3, v0
  v_mul_u32_u24 v10, 4224, v10
  v_bfe_u32 v11, v0, 1, 1
  v_lshl_add_u32 v10, v11, 11, v10
  v_bfe_u32 v11, v0, 2, 1
  v_lshl_add_u32 v10, v11, 5, v10
  v_and_b32 v11, 1, v0
  v_lshl_add_u32 v10, v11, 4, v10
  s_mov_b32 m0, s65
  s_nop 0
  buffer_load_dwordx4 v10, s[4:7], s64 offen sc1 lds
  v_mov_b32 v10, 163328
  s_mov_b32 s96, 400000
LB_52:
  ds_read_b32 v11, v10 offset:40
  s_waitcnt lgkmcnt(0)
  v_readfirstlane_b32 s55, v11
  s_nop 0
  s_cmp_ge_u32 s55, 8
  s_cbranch_scc1 LBD_53
  s_sub_u32 s96, s96, 1
  s_cmp_lg_u32 s96, 0
  s_cbranch_scc1 LB_52
  s_or_b32 s97, s97, 2048
LBD_53:
  v_mfma_f32_32x32x16_bf16 v[48:63], v[80:83], a[80:83], 0
  v_mfma_f32_32x32x16_bf16 v[64:79], v[84:87], a[80:83], 0
  v_mfma_f32_32x32x16_bf16 v[48:63], v[88:91], a[84:87], v[48:63]
  ds_write_b128 v15, v[16:19] offset:0
  v_mfma_f32_32x32x16_bf16 v[64:79], v[92:95], a[84:87], v[64:79]
  s_waitcnt vmcnt(12)
  v_mfma_f32_32x32x16_bf16 v[48:63], v[96:99], a[88:91], v[48:63]
  ds_write_b128 v15, v[20:23] offset:1024
  v_mfma_f32_32x32x16_bf16 v[64:79], v[100:103], a[88:91], v[64:79]
  s_waitcnt vmcnt(11)
  v_mfma_f32_32x32x16_bf16 v[48:63], v[104:107], a[92:95], v[48:63]
  v_mfma_f32_32x32x16_bf16 v[64:79], v[108:111], a[92:95], v[64:79]
  ds_write_b128 v15, v[24:27] offset:4096
  s_waitcnt vmcnt(10)
  v_mfma_f32_32x32x16_bf16 v[48:63], v[112:115], a[96:99], v[48:63]
  v_mfma_f32_32x32x16_bf16 v[64:79], v[116:119], a[96:99], v[64:79]
  s_waitcnt vmcnt(9)
  v_mfma_f32_32x32x16_bf16 v[48:63], v[120:123], a[100:103], v[48:63]
  ds_write_b128 v15, v[28:31] offset:5120
  v_mfma_f32_32x32x16_bf16 v[64:79], v[124:127], a[100:103], v[64:79]
  s_waitcnt vmcnt(8)
  v_mfma_f32_32x32x16_bf16 v[48:63], v[128:131], a[104:107], v[48:63]
  ds_write_b128 v15, v[32:35] offset:8192
  v_mfma_f32_32x32x16_bf16 v[64:79], v[132:135], a[104:107], v[64:79]
  s_waitcnt vmcnt(7)
  v_mfma_f32_32x32x16_bf16 v[48:63], a[0:3], a[108:111], v[48:63]
  v_mfma_f32_32x32x16_bf16 v[64:79], a[4:7], a[108:111], v[64:79]
  ds_write_b128 v15, v[36:39] offset:9216
  s_waitcnt vmcnt(6)
  v_mfma_f32_32x32x16_bf16 v[48:63], a[8:11], a[56:59], v[48:63]
  v_mfma_f32_32x32x16_bf16 v[64:79], a[12:15], a[56:59], v[64:79]
  global_load_dwordx4 v[80:83], v14, s[100:101]
  s_waitcnt vmcnt(1)
  ds_read_b64_tr_b16 v[84:85], v3 offset:0
  ds_read_b64_tr_b16 v[86:87], v3 offset:512
  v_accvgpr_read_b32 v88, a112
  v_accvgpr_read_b32 v89, a113
  v_accvgpr_read_b32 v90, a114
  v_accvgpr_read_b32 v91, a115
  v_mfma_f32_32x32x16_bf16 v[48:63], a[16:19], a[60:63], v[48:63]
  ds_write_b128 v15, v[40:43] offset:12288
  v_mfma_f32_32x32x16_bf16 v[64:79], a[20:23], a[60:63], v[64:79]
  v_mfma_f32_32x32x16_bf16 v[48:63], a[24:27], a[64:67], v[48:63]
  ds_write_b128 v15, v[44:47] offset:13312
  v_mfma_f32_32x32x16_bf16 v[64:79], a[28:31], a[64:67], v[64:79]
  v_mfma_f32_32x32x16_bf16 v[48:63], a[32:35], a[68:71], v[48:63]
  v_mfma_f32_32x32x16_bf16 v[64:79], a[36:39], a[68:71], v[64:79]
  v_mfma_f32_32x32x16_bf16 v[48:63], a[40:43], a[72:75], v[48:63]
  v_mfma_f32_32x32x16_bf16 v[64:79], a[44:47], a[72:75], v[64:79]
  v_mfma_f32_32x32x16_bf16 v[48:63], a[48:51], a[76:79], v[48:63]
  v_mfma_f32_32x32x16_bf16 v[64:79], a[52:55], a[76:79], v[64:79]
  v_add_u32 v12, 0x10000, v4
  s_waitcnt lgkmcnt(0)
  s_nop 8
  ds_write_b128 v15, v[48:51] offset:512
  ds_write_b128 v15, v[52:55] offset:1536
  ds_write_b128 v15, v[56:59] offset:4608
  ds_write_b128 v15, v[60:63] offset:5632
  ds_write_b128 v15, v[64:67] offset:8704
  ds_write_b128 v15, v[68:71] offset:9728
  ds_write_b128 v15, v[72:75] offset:12800
  ds_write_b128 v15, v[76:79] offset:13824
MERGE:
  v_lshlrev_b32 v96, 16, v88
  v_and_b32 v97, 0xffff0000, v88
  v_lshlrev_b32 v98, 16, v89
  v_and_b32 v99, 0xffff0000, v89
  v_lshlrev_b32 v100, 16, v90
  v_and_b32 v101, 0xffff0000, v90
  v_lshlrev_b32 v102, 16, v91
  v_and_b32 v103, 0xffff0000, v91
  v_lshlrev_b32 v104, 16, v84
  v_and_b32 v105, 0xffff0000, v84
  v_lshlrev_b32 v106, 16, v85
  v_and_b32 v107, 0xffff0000, v85
  v_lshlrev_b32 v108, 16, v86
  v_and_b32 v109, 0xffff0000, v86
  v_lshlrev_b32 v110, 16, v87
  v_and_b32 v111, 0xffff0000, v87
  s_waitcnt vmcnt(0)
  v_lshlrev_b32 v112, 16, v80
  v_and_b32 v113, 0xffff0000, v80
  v_lshlrev_b32 v114, 16, v81
  v_and_b32 v115, 0xffff0000, v81
  v_lshlrev_b32 v116, 16, v82
  v_and_b32 v117, 0xffff0000, v82
  v_lshlrev_b32 v118, 16, v83
  v_and_b32 v119, 0xffff0000, v83
  s_waitcnt lgkmcnt(0)
  s_barrier
  ds_read_b128 v[16:19], v4 offset:0
  ds_read_b128 v[20:23], v4 offset:1024
  ds_read_b128 v[24:27], v4 offset:16384
  ds_read_b128 v[28:31], v4 offset:17408
  ds_read_b128 v[32:35], v4 offset:32768
  ds_read_b128 v[36:39], v4 offset:33792
  ds_read_b128 v[40:43], v4 offset:49152
  ds_read_b128 v[44:47], v4 offset:50176
  ds_read_b128 v[48:51], v12 offset:0
  ds_read_b128 v[52:55], v12 offset:1024
  ds_read_b128 v[56:59], v12 offset:16384
  ds_read_b128 v[60:63], v12 offset:17408
  ds_read_b128 v[64:67], v12 offset:32768
  ds_read_b128 v[68:71], v12 offset:33792
  ds_read_b128 v[72:75], v12 offset:49152
  ds_read_b128 v[76:79], v12 offset:50176
  s_waitcnt lgkmcnt(14)
  v_pk_add_f32 v[96:97], v[96:97], v[16:17]
  v_pk_add_f32 v[98:99], v[98:99], v[18:19]
  v_pk_add_f32 v[100:101], v[100:101], v[20:21]
  v_pk_add_f32 v[102:103], v[102:103], v[22:23]
  s_waitcnt lgkmcnt(12)
  v_pk_add_f32 v[96:97], v[96:97], v[24:25]
  v_pk_add_f32 v[98:99], v[98:99], v[26:27]
  v_pk_add_f32 v[100:101], v[100:101], v[28:29]
  v_pk_add_f32 v[102:103], v[102:103], v[30:31]
  s_waitcnt lgkmcnt(10)
  v_pk_add_f32 v[96:97], v[96:97], v[32:33]
  v_pk_add_f32 v[98:99], v[98:99], v[34:35]
  v_pk_add_f32 v[100:101], v[100:101], v[36:37]
  v_pk_add_f32 v[102:103], v[102:103], v[38:39]
  s_waitcnt lgkmcnt(8)
  v_pk_add_f32 v[96:97], v[96:97], v[40:41]
  v_pk_add_f32 v[98:99], v[98:99], v[42:43]
  v_pk_add_f32 v[100:101], v[100:101], v[44:45]
  v_pk_add_f32 v[102:103], v[102:103], v[46:47]
  s_waitcnt lgkmcnt(6)
  v_pk_add_f32 v[96:97], v[96:97], v[48:49]
  v_pk_add_f32 v[98:99], v[98:99], v[50:51]
  v_pk_add_f32 v[100:101], v[100:101], v[52:53]
  v_pk_add_f32 v[102:103], v[102:103], v[54:55]
  s_waitcnt lgkmcnt(4)
  v_pk_add_f32 v[96:97], v[96:97], v[56:57]
  v_pk_add_f32 v[98:99], v[98:99], v[58:59]
  v_pk_add_f32 v[100:101], v[100:101], v[60:61]
  v_pk_add_f32 v[102:103], v[102:103], v[62:63]
  s_waitcnt lgkmcnt(2)
  v_pk_add_f32 v[96:97], v[96:97], v[64:65]
  v_pk_add_f32 v[98:99], v[98:99], v[66:67]
  v_pk_add_f32 v[100:101], v[100:101], v[68:69]
  v_pk_add_f32 v[102:103], v[102:103], v[70:71]
  s_waitcnt lgkmcnt(0)
  v_pk_add_f32 v[96:97], v[96:97], v[72:73]
  v_pk_add_f32 v[98:99], v[98:99], v[74:75]
  v_pk_add_f32 v[100:101], v[100:101], v[76:77]
  v_pk_add_f32 v[102:103], v[102:103], v[78:79]
  v_mov_b32 v16, 0xbfb8aa3b
  v_pk_mul_f32 v[120:121], v[96:97], v[16:17] op_sel_hi:[1,0]
  v_pk_mul_f32 v[122:123], v[98:99], v[16:17] op_sel_hi:[1,0]
  v_pk_mul_f32 v[124:125], v[100:101], v[16:17] op_sel_hi:[1,0]
  v_pk_mul_f32 v[126:127], v[102:103], v[16:17] op_sel_hi:[1,0]
  v_exp_f32 v120, v120
  v_exp_f32 v121, v121
  v_exp_f32 v122, v122
  v_exp_f32 v123, v123
  v_exp_f32 v124, v124
  v_exp_f32 v125, v125
  v_exp_f32 v126, v126
  v_exp_f32 v127, v127
  v_pk_mul_f32 v[96:97], v[96:97], v[104:105]
  v_pk_mul_f32 v[98:99], v[98:99], v[106:107]
  v_pk_mul_f32 v[100:101], v[100:101], v[108:109]
  v_pk_mul_f32 v[102:103], v[102:103], v[110:111]
  v_pk_add_f32 v[120:121], v[120:121], 1.0 op_sel_hi:[1,0]
  v_pk_add_f32 v[122:123], v[122:123], 1.0 op_sel_hi:[1,0]
  v_pk_add_f32 v[124:125], v[124:125], 1.0 op_sel_hi:[1,0]
  v_pk_add_f32 v[126:127], v[126:127], 1.0 op_sel_hi:[1,0]
  v_rcp_f32 v120, v120
  v_rcp_f32 v121, v121
  v_rcp_f32 v122, v122
  v_rcp_f32 v123, v123
  v_rcp_f32 v124, v124
  v_rcp_f32 v125, v125
  v_rcp_f32 v126, v126
  v_rcp_f32 v127, v127
  v_pk_fma_f32 v[96:97], v[96:97], v[120:121], v[112:113]
  v_pk_fma_f32 v[98:99], v[98:99], v[122:123], v[114:115]
  v_pk_fma_f32 v[100:101], v[100:101], v[124:125], v[116:117]
  v_pk_fma_f32 v[102:103], v[102:103], v[126:127], v[118:119]
  v_cvt_pk_bf16_f32 v16, v96, v97
  v_cvt_pk_bf16_f32 v17, v98, v99
  v_cvt_pk_bf16_f32 v18, v100, v101
  v_cvt_pk_bf16_f32 v19, v102, v103
  global_store_dwordx4 v14, v[16:19], s[44:45]
FIN:
END:
  s_endpgm
SROLE:
  s_setprio 1
  s_lshl_b32 s55, s51, 6
  s_lshl_b32 s56, s50, 1
  s_add_u32 s75, s55, s56
  s_add_u32 s74, s75, s53
  s_lshl_b32 s75, s75, 1
  s_lshl_b32 s55, s74, 9
  s_lshl_b32 s56, s54, 8
  s_add_u32 s55, s55, s56
  v_lshl_add_u32 v41, v0, 2, s55
  s_mov_b32 s10, 401408
  s_mov_b32 s11, 0x20000
  s_and_b32 s55, s50, 3
  s_mul_i32 s62, s55, 7
  s_add_u32 s62, s62, 1
  s_lshr_b32 s62, s62, 1
  s_lshl_b32 s62, s62, 10
  s_mul_i32 s93, s52, 100352
  s_lshl_b32 s56, s51, 7
  s_add_u32 s93, s93, s56
  s_mul_i32 s94, s52, 14336
  s_add_u32 s94, s94, 104448
  v_lshrrev_b32 v43, 3, v0
  v_mul_u32_u24 v42, 896, v43
  v_lshlrev_b32 v43, 1, v43
  v_and_b32 v43, 4, v43
  v_and_b32 v40, 7, v0
  v_xor_b32 v43, v43, v40
  v_lshl_add_u32 v42, v43, 4, v42
  v_mov_b32 v43, 0
  v_lshlrev_b32 v29, 2, v0
  v_add_u32 v29, 163328, v29
  s_mov_b32 exec_hi, 0
  ds_write_b32 v29, v43
  s_mov_b64 exec, -1
  s_waitcnt lgkmcnt(0)
  s_load_dword s34, s[30:31], s75
  s_load_dword s35, s[32:33], s75
  s_mov_b32 s4, s46
  s_mov_b32 s5, s47
  s_mov_b32 s6, 33554432
  s_mov_b32 s7, 0x20000
  s_load_dwordx2 s[48:49], s[46:47], 0
  v_lshlrev_b32 v1, 10, v15
  v_lshl_add_u32 v1, v14, 4, v1
  s_mul_i32 s55, s51, 3328
  s_lshl_b32 s56, s50, 3
  s_add_u32 s55, s55, s56
  s_add_u32 s55, s55, 917504
  v_mul_u32_u24 v3, 26624, v0
  v_add_u32 v3, s55, v3
  s_mul_i32 s90, s50, 26624
  s_add_u32 s90, s90, 917504
  s_mul_i32 s56, s51, 3328
  s_add_u32 s92, s56, s90
  v_lshl_add_u32 v6, v0, 3, s92
  s_lshl_b32 s57, s51, 3
  s_add_u32 s57, s57, s90
  v_mul_u32_u24 v5, 3328, v0
  v_add_u32 v5, s57, v5
  s_mul_i32 s66, s50, 57344
  s_mov_b32 s100, s16
  s_mov_b32 s101, s17
  s_mov_b32 s84, -1
  s_mov_b32 s85, 0
  s_mov_b32 s68, 0x3f803f80
  s_mov_b32 s69, 0x00003f80
  s_mov_b32 s70, 0x3f800000
  s_lshr_b32 s55, s91, 1
  s_lshl_b32 s76, s51, 2
  s_add_u32 s76, s76, s55
  s_mul_i32 s76, s76, 59392
  s_and_b32 s55, s91, 1
  s_lshl_b32 s55, s55, 10
  s_add_u32 s76, s76, s55
  s_add_u32 s76, s76, 11534336
  s_mul_i32 s77, s51, 229376
  s_lshl_b32 s55, s91, 12
  s_add_u32 s77, s77, s55
  s_add_u32 s77, s77, 13631488
  s_mul_i32 s83, s50, 230400
  s_add_u32 s83, s83, s55
  s_add_u32 s83, s83, 16777216
  s_lshl_b32 s55, s51, 15
  s_add_u32 s80, s83, s55
  v_mov_b32 v12, v2
  s_mov_b32 s55, s51
  s_cmp_ge_u32 s55, 7
  s_cselect_b32 s56, 7, 0
  s_sub_u32 s55, s55, s56
  s_lshl_b32 s12, s55, 15
  s_add_u32 s55, s55, 1
  s_cmp_ge_u32 s55, 7
  s_cselect_b32 s56, 7, 0
  s_sub_u32 s55, s55, s56
  s_lshl_b32 s13, s55, 15
  s_add_u32 s55, s55, 1
  s_cmp_ge_u32 s55, 7
  s_cselect_b32 s56, 7, 0
  s_sub_u32 s55, s55, s56
  s_lshl_b32 s14, s55, 15
  s_add_u32 s55, s55, 1
  s_cmp_ge_u32 s55, 7
  s_cselect_b32 s56, 7, 0
  s_sub_u32 s55, s55, s56
  s_lshl_b32 s15, s55, 15
  s_add_u32 s55, s55, 1
  s_cmp_ge_u32 s55, 7
  s_cselect_b32 s56, 7, 0
  s_sub_u32 s55, s55, s56
  s_lshl_b32 s81, s55, 15
  s_add_u32 s55, s55, 1
  s_cmp_ge_u32 s55, 7
  s_cselect_b32 s56, 7, 0
  s_sub_u32 s55, s55, s56
  s_lshl_b32 s82, s55, 15
  s_add_u32 s55, s55, 1
  s_cmp_ge_u32 s55, 7
  s_cselect_b32 s56, 7, 0
  s_sub_u32 s55, s55, s56
  s_lshl_b32 s3, s55, 15
  v_and_b32 v29, 3, v0
  s_mul_i32 s72, s53, 17408
  v_and_b32 v43, 3, v0
  v_sub_u32 v38, 3, v43
  v_mul_u32_u24 v38, 4160, v38
  v_bfe_u32 v43, v0, 2, 2
  v_lshlrev_b32 v43, 3, v43
  v_sub_u32 v38, v38, v43
  v_lshrrev_b32 v43, 4, v0
  v_lshl_add_u32 v38, v43, 4, v38
  s_mul_i32 s57, s53, 17408
  s_lshl_b32 s56, s54, 5
  s_sub_u32 s55, s57, s56
  s_add_u32 s55, s55, 56
  v_add_u32 v38, s55, v38
  s_mul_i32 s55, s53, 6144
  s_add_u32 s55, s55, 34816
  s_mul_i32 s56, s54, 3072
  s_add_u32 s58, s55, s56
  v_mul_u32_u24 v39, 1536, v43
  v_and_b32 v43, 15, v0
  v_lshl_add_u32 v39, v43, 4, v39
  v_add_u32 v39, s55, v39
  s_lshl_b32 s55, s51, 6
  s_lshl_b32 s56, s50, 1
  s_add_u32 s59, s55, s56
  s_add_u32 s59, s59, s53
  s_mul_i32 s59, s59, 4224
  s_mov_b32 s78, s58
  v_mul_u32_u24 v40, 1536, v15
  v_lshl_add_u32 v40, v14, 4, v40
  v_add_u32 v40, s78, v40
  s_mul_i32 s73, s52, 8704
  v_mul_u32_u24 v28, 272, v14
  v_lshl_add_u32 v28, v15, 4, v28
  v_add_u32 v28, s73, v28
  s_mov_b32 s74, s59
  s_mul_i32 s79, s53, 12
  s_add_u32 s79, s79, 163328
  s_barrier
  global_load_dword v16, v41, s[18:19]
  global_load_dword v17, v41, s[20:21]
  global_load_dword v18, v41, s[22:23]
  global_load_dword v19, v41, s[24:25]
  global_load_dword v20, v41, s[26:27]
  global_load_dword v21, v41, s[28:29]
  v_lshrrev_b32 v42, 3, v0
  v_mul_u32_u24 v42, 896, v42
  v_and_b32 v43, 7, v0
  v_lshl_add_u32 v42, v43, 4, v42
  s_and_b32 s55, s50, 3
  s_mul_i32 s55, s55, 112
  s_mul_i32 s56, s52, 27
  s_min_u32 s56, s56, 80
  s_add_u32 s55, s55, s56
  s_mul_i32 s55, s55, 896
  s_lshl_b32 s56, s51, 7
  s_add_u32 s55, s55, s56
  v_add_u32 v42, s55, v42
  global_load_dwordx4 v[128:131], v42, s[38:39]
  v_add_u32 v42, 7168, v42
  global_load_dwordx4 v[128:131], v42, s[38:39]
  v_add_u32 v42, 7168, v42
  global_load_dwordx4 v[128:131], v42, s[38:39]
  v_add_u32 v42, 7168, v42
  global_load_dwordx4 v[128:131], v42, s[38:39]
  v_lshl_add_u32 v42, v0, 6, s92
  s_mov_b32 exec_hi, 0xfffff
  buffer_load_dword v132, v42, s[4:7], 0 offen sc1
  s_mov_b32 exec_hi, -1
  s_waitcnt lgkmcnt(0)
  s_add_u32 s48, s48, 1
  s_addc_u32 s49, s49, 0
  v_mov_b32 v8, s48
  v_mov_b32 v9, s49
  v_add_u32 v92, 161792, v2
  v_bfe_u32 v99, v0, 1, 3
  s_lshl_b32 s56, s52, 1
  v_xor_b32 v99, s56, v99
  v_lshlrev_b32 v99, 4, v99
  v_mul_u32_u24 v98, 896, v0
  s_lshl_b32 s55, s51, 7
  s_add_u32 s55, s55, 47104
  v_add3_u32 v93, v99, s55, v98
  v_xor_b32 v99, 16, v99
  v_add3_u32 v94, v99, s55, v98
  s_mul_i32 s55, s52, 3072
  s_add_u32 s55, s55, 34816
  v_lshl_add_u32 v95, v0, 5, s55
  v_lshrrev_b32 v98, 4, v0
  v_bfe_u32 v96, v0, 2, 2
  v_lshl_add_u32 v96, v98, 4, v96
  v_lshl_add_u32 v96, v96, 5, s55
  v_lshl_add_u32 v96, v29, 3, v96
  v_and_b32 v97, 15, v0
  v_mul_u32_u24 v97, 144, v97
  v_lshl_add_u32 v97, v98, 5, v97
  v_add_u32 v97, s55, v97
  v_lshrrev_b32 v99, 3, v0
  v_mul_u32_u24 v98, 144, v99
  v_mul_u32_u24 v99, 4224, v99
  v_and_b32 v100, 7, v0
  v_lshl_add_u32 v98, v100, 4, v98
  v_add_u32 v98, s55, v98
  v_lshl_add_u32 v99, v100, 4, v99
  s_lshl_b32 s55, s51, 6
  s_lshl_b32 s56, s52, 4
  s_add_u32 s55, s55, s56
  s_mul_i32 s55, s55, 4224
  s_lshl_b32 s56, s50, 7
  s_add_u32 s55, s55, s56
  s_add_u32 s60, s55, 4194304
  s_add_u32 s61, s60, 33792
  s_barrier
  ds_read_b128 v[100:103], v92
  ds_read_b128 v[104:107], v93
  ds_read_b128 v[108:111], v94
  s_waitcnt lgkmcnt(0)
  v_mov_b32 v10, 163328
  v_mov_b32 v11, 1
  s_mov_b64 exec, 1
  ds_add_rtn_u32 v11, v10, v11 offset:56
  s_mov_b64 exec, -1
  v_mul_f32 v100, v100, v101
  v_lshlrev_b32 v112, 16, v104
  v_and_b32 v113, 0xffff0000, v104
  v_lshlrev_b32 v114, 16, v105
  v_and_b32 v115, 0xffff0000, v105
  v_lshlrev_b32 v116, 16, v106
  v_and_b32 v117, 0xffff0000, v106
  v_lshlrev_b32 v118, 16, v107
  v_and_b32 v119, 0xffff0000, v107
  v_lshlrev_b32 v120, 16, v108
  v_and_b32 v121, 0xffff0000, v108
  v_lshlrev_b32 v122, 16, v109
  v_and_b32 v123, 0xffff0000, v109
  v_lshlrev_b32 v124, 16, v110
  v_and_b32 v125, 0xffff0000, v110
  v_lshlrev_b32 v126, 16, v111
  v_and_b32 v127, 0xffff0000, v111
  v_fma_f32 v112, v112, v101, -v100
  v_fma_f32 v113, v113, v101, -v100
  v_fma_f32 v114, v114, v101, -v100
  v_fma_f32 v115, v115, v101, -v100
  v_fma_f32 v116, v116, v101, -v100
  v_fma_f32 v117, v117, v101, -v100
  v_fma_f32 v118, v118, v101, -v100
  v_fma_f32 v119, v119, v101, -v100
  v_fma_f32 v120, v120, v101, -v100
  v_fma_f32 v121, v121, v101, -v100
  v_fma_f32 v122, v122, v101, -v100
  v_fma_f32 v123, v123, v101, -v100
  v_fma_f32 v124, v124, v101, -v100
  v_fma_f32 v125, v125, v101, -v100
  v_fma_f32 v126, v126, v101, -v100
  v_fma_f32 v127, v127, v101, -v100
  v_cvt_pk_f16_f32 v104, v112, v113
  v_cvt_pk_f16_f32 v105, v114, v115
  v_cvt_pk_f16_f32 v106, v116, v117
  v_cvt_pk_f16_f32 v107, v118, v119
  v_cvt_pk_f16_f32 v108, v120, v121
  v_cvt_pk_f16_f32 v109, v122, v123
  v_cvt_pk_f16_f32 v110, v124, v125
  v_cvt_pk_f16_f32 v111, v126, v127
  ds_write_b128 v95, v[104:107]
  ds_write_b128 v95, v[108:111] offset:16
  ds_read_b64_tr_b16 v[104:105], v96 offset:0
  ds_read_b64_tr_b16 v[106:107], v96 offset:128
  ds_read_b64_tr_b16 v[108:109], v96 offset:256
  ds_read_b64_tr_b16 v[110:111], v96 offset:384
  s_waitcnt lgkmcnt(0)
  ds_write_b128 v97, v[104:107]
  ds_write_b128 v97, v[108:111] offset:16
  ds_read_b128 v[104:107], v98
  ds_read_b128 v[108:111], v98 offset:1152
  s_waitcnt lgkmcnt(0)
  buffer_store_dwordx4 v[104:107], v99, s[4:7], s60 offen sc1
  buffer_store_dwordx4 v[108:111], v99, s[4:7], s61 offen sc1
  s_waitcnt vmcnt(7)
  s_lshl_b32 s55, s53, 4
  s_lshr_b32 s56, s34, s55
  s_lshl_b32 s56, s56, 16
  s_lshr_b32 s35, s35, s55
  s_lshl_b32 s35, s35, 16
  v_mov_b32 v27, 0x3fb8aa3b
  v_mul_f32 v27, s56, v27
  v_exp_f32 v27, v27
  s_nop 0
  v_cvt_pk_bf16_f32 v27, v27, v27
  v_and_b32 v27, 0xffff0000, v27
  v_lshlrev_b32 v92, 16, v18
  v_lshlrev_b32 v93, 16, v19
  v_lshlrev_b32 v94, 16, v20
  v_lshlrev_b32 v95, 16, v21
  v_and_b32 v96, 0xffff0000, v18
  v_and_b32 v97, 0xffff0000, v19
  v_and_b32 v98, 0xffff0000, v20
  v_and_b32 v99, 0xffff0000, v21
  v_pk_mul_f32 v[22:23], v[92:93], v[94:95] op_sel_hi:[1,0]
  v_pk_mul_f32 v[24:25], v[96:97], v[98:99] op_sel_hi:[1,0]
  v_pk_fma_f32 v[22:23], v[92:93], v[94:95], v[22:23] op_sel:[1,1,0] op_sel_hi:[0,1,1] neg_lo:[1,0,0]
  v_pk_fma_f32 v[24:25], v[96:97], v[98:99], v[24:25] op_sel:[1,1,0] op_sel_hi:[0,1,1] neg_lo:[1,0,0]
  v_max_f32 v26, abs(v22), abs(v23)
  v_max3_f32 v26, abs(v24), abs(v25), v26
  s_nop 1
  v_max_f32_dpp v26, v26, v26 row_ror:8 row_mask:0xf bank_mask:0xf
  s_nop 1
  v_max_f32_dpp v26, v26, v26 row_ror:4 row_mask:0xf bank_mask:0xf
  s_nop 1
  v_max_f32_dpp v26, v26, v26 row_ror:2 row_mask:0xf bank_mask:0xf
  s_nop 1
  v_max_f32_dpp v26, v26, v26 row_ror:1 row_mask:0xf bank_mask:0xf
  v_mov_b32 v92, v26
  s_nop 1
  v_permlane16_swap_b32 v92, v26
  v_max_f32 v26, v26, v92
  v_mov_b32 v92, v26
  s_nop 1
  v_permlane32_swap_b32 v92, v26
  v_max_f32 v26, v26, v92
  v_frexp_exp_i32_f32 v26, v26
  v_sub_u32 v92, 0, v26
  v_ldexp_f32 v22, v22, v92
  v_ldexp_f32 v23, v23, v92
  v_ldexp_f32 v24, v24, v92
  v_ldexp_f32 v25, v25, v92
  v_and_b32 v94, 0xffff0000, v16
  v_and_b32 v95, 0xffff0000, v17
  v_mul_f32 v94, v94, v27
  v_mul_f32 v95, v95, v27
  v_mul_f32 v94, 0x3fb8aa3b, v94
  v_mul_f32 v95, 0x3e22f983, v95
  v_mov_b32 v92, v24
  v_mov_b32 v93, v25
  s_mul_i32 s55, s52, 3072
  s_add_u32 s55, s55, 34816
  v_add_u32 v96, s55, v2
  ds_write_b128 v96, v[92:95]
  s_lshl_b32 s55, s52, 2
  s_add_u32 s55, s55, 163392
  v_mov_b32 v10, s55
  v_mov_b32 v11, 1
  s_mov_b64 exec, 1
  ds_add_u32 v10, v11
  s_mov_b64 exec, -1
  s_mov_b32 m0, s73
  v_lshlrev_b32 v92, 16, v16
  v_lshlrev_b32 v93, 16, v17
  v_mul_f32 v92, v92, v27
  v_mul_f32 v93, v93, v27
  v_mul_f32 v92, 0x3fb8aa3b, v92
  v_mul_f32 v93, 0x3e22f983, v93
  v_mul_f32 v100, 0x41000000, v92
  v_mul_f32 v101, 0x41000000, v93
  v_mul_f32 v102, 0x43800000, v92
  v_mul_f32 v103, 0x43800000, v93
  v_fract_f32 v93, v93
  v_fract_f32 v101, v101
  v_fract_f32 v103, v103
  v_exp_f32 v100, v100
  v_cos_f32 v96, v101
  v_sin_f32 v97, v101
  v_exp_f32 v92, v92
  v_cos_f32 v32, v93
  v_sin_f32 v33, v93
  v_exp_f32 v102, v102
  v_cos_f32 v34, v103
  v_sin_f32 v35, v103
  v_pk_mul_f32 v[96:97], v[96:97], v[100:101] op_sel_hi:[1,0]
  v_pk_mul_f32 v[32:33], v[32:33], v[92:93] op_sel_hi:[1,0]
  v_pk_mul_f32 v[34:35], v[34:35], v[102:103] op_sel_hi:[1,0]
  v_mov_b32 v100, 1.0
  v_mov_b32 v101, 0
  v_mov_b32 v102, v96
  v_mov_b32 v103, v97
  v_pk_mul_f32 v[104:105], v[96:97], v[96:97] op_sel_hi:[1,0]
  v_pk_mul_f32 v[30:31], v[32:33], v[32:33] op_sel_hi:[1,0]
  v_pk_fma_f32 v[104:105], v[96:97], v[96:97], v[104:105] op_sel:[1,1,0] op_sel_hi:[0,1,1] neg_lo:[1,0,0]
  v_pk_fma_f32 v[30:31], v[32:33], v[32:33], v[30:31] op_sel:[1,1,0] op_sel_hi:[0,1,1] neg_lo:[1,0,0]
  v_pk_mul_f32 v[106:107], v[104:105], v[96:97] op_sel_hi:[1,0]
  v_pk_mul_f32 v[116:117], v[104:105], v[104:105] op_sel_hi:[1,0]
  v_pk_fma_f32 v[106:107], v[104:105], v[96:97], v[106:107] op_sel:[1,1,0] op_sel_hi:[0,1,1] neg_lo:[1,0,0]
  v_pk_fma_f32 v[116:117], v[104:105], v[104:105], v[116:117] op_sel:[1,1,0] op_sel_hi:[0,1,1] neg_lo:[1,0,0]
  v_pk_mul_f32 v[108:109], v[100:101], v[116:117] op_sel_hi:[1,0]
  v_cvt_pk_f16_f32 v118, v100, v101
  v_pk_mul_f32 v[110:111], v[102:103], v[116:117] op_sel_hi:[1,0]
  v_cvt_pk_f16_f32 v119, v102, v103
  v_pk_mul_f32 v[112:113], v[104:105], v[116:117] op_sel_hi:[1,0]
  v_cvt_pk_f16_f32 v120, v104, v105
  v_pk_mul_f32 v[114:115], v[106:107], v[116:117] op_sel_hi:[1,0]
  v_cvt_pk_f16_f32 v121, v106, v107
  v_pk_fma_f32 v[108:109], v[100:101], v[116:117], v[108:109] op_sel:[1,1,0] op_sel_hi:[0,1,1] neg_lo:[1,0,0]
  ds_write_addtid_b32 v118 offset:0
  v_pk_fma_f32 v[110:111], v[102:103], v[116:117], v[110:111] op_sel:[1,1,0] op_sel_hi:[0,1,1] neg_lo:[1,0,0]
  ds_write_addtid_b32 v119 offset:272
  v_pk_fma_f32 v[112:113], v[104:105], v[116:117], v[112:113] op_sel:[1,1,0] op_sel_hi:[0,1,1] neg_lo:[1,0,0]
  ds_write_addtid_b32 v120 offset:544
  v_pk_fma_f32 v[114:115], v[106:107], v[116:117], v[114:115] op_sel:[1,1,0] op_sel_hi:[0,1,1] neg_lo:[1,0,0]
  ds_write_addtid_b32 v121 offset:816
  v_pk_mul_f32 v[100:101], v[108:109], v[116:117] op_sel_hi:[1,0]
  v_cvt_pk_f16_f32 v118, v108, v109
  v_pk_mul_f32 v[102:103], v[110:111], v[116:117] op_sel_hi:[1,0]
  v_cvt_pk_f16_f32 v119, v110, v111
  v_pk_mul_f32 v[104:105], v[112:113], v[116:117] op_sel_hi:[1,0]
  v_cvt_pk_f16_f32 v120, v112, v113
  v_pk_mul_f32 v[106:107], v[114:115], v[116:117] op_sel_hi:[1,0]
  v_cvt_pk_f16_f32 v121, v114, v115
  v_pk_fma_f32 v[100:101], v[108:109], v[116:117], v[100:101] op_sel:[1,1,0] op_sel_hi:[0,1,1] neg_lo:[1,0,0]
  ds_write_addtid_b32 v118 offset:1088
  v_pk_fma_f32 v[102:103], v[110:111], v[116:117], v[102:103] op_sel:[1,1,0] op_sel_hi:[0,1,1] neg_lo:[1,0,0]
  ds_write_addtid_b32 v119 offset:1360
  v_pk_fma_f32 v[104:105], v[112:113], v[116:117], v[104:105] op_sel:[1,1,0] op_sel_hi:[0,1,1] neg_lo:[1,0,0]
  ds_write_addtid_b32 v120 offset:1632
  v_pk_fma_f32 v[106:107], v[114:115], v[116:117], v[106:107] op_sel:[1,1,0] op_sel_hi:[0,1,1] neg_lo:[1,0,0]
  ds_write_addtid_b32 v121 offset:1904
  v_pk_mul_f32 v[108:109], v[100:101], v[116:117] op_sel_hi:[1,0]
  v_cvt_pk_f16_f32 v118, v100, v101
  v_pk_mul_f32 v[110:111], v[102:103], v[116:117] op_sel_hi:[1,0]
  v_cvt_pk_f16_f32 v119, v102, v103
  v_pk_mul_f32 v[112:113], v[104:105], v[116:117] op_sel_hi:[1,0]
  v_cvt_pk_f16_f32 v120, v104, v105
  v_pk_mul_f32 v[114:115], v[106:107], v[116:117] op_sel_hi:[1,0]
  v_cvt_pk_f16_f32 v121, v106, v107
  v_pk_fma_f32 v[108:109], v[100:101], v[116:117], v[108:109] op_sel:[1,1,0] op_sel_hi:[0,1,1] neg_lo:[1,0,0]
  ds_write_addtid_b32 v118 offset:2176
  v_pk_fma_f32 v[110:111], v[102:103], v[116:117], v[110:111] op_sel:[1,1,0] op_sel_hi:[0,1,1] neg_lo:[1,0,0]
  ds_write_addtid_b32 v119 offset:2448
  v_pk_fma_f32 v[112:113], v[104:105], v[116:117], v[112:113] op_sel:[1,1,0] op_sel_hi:[0,1,1] neg_lo:[1,0,0]
  ds_write_addtid_b32 v120 offset:2720
  v_pk_fma_f32 v[114:115], v[106:107], v[116:117], v[114:115] op_sel:[1,1,0] op_sel_hi:[0,1,1] neg_lo:[1,0,0]
  ds_write_addtid_b32 v121 offset:2992
  v_pk_mul_f32 v[100:101], v[108:109], v[116:117] op_sel_hi:[1,0]
  v_cvt_pk_f16_f32 v118, v108, v109
  v_pk_mul_f32 v[102:103], v[110:111], v[116:117] op_sel_hi:[1,0]
  v_cvt_pk_f16_f32 v119, v110, v111
  v_pk_mul_f32 v[104:105], v[112:113], v[116:117] op_sel_hi:[1,0]
  v_cvt_pk_f16_f32 v120, v112, v113
  v_pk_mul_f32 v[106:107], v[114:115], v[116:117] op_sel_hi:[1,0]
  v_cvt_pk_f16_f32 v121, v114, v115
  v_pk_fma_f32 v[100:101], v[108:109], v[116:117], v[100:101] op_sel:[1,1,0] op_sel_hi:[0,1,1] neg_lo:[1,0,0]
  ds_write_addtid_b32 v118 offset:3264
  v_pk_fma_f32 v[102:103], v[110:111], v[116:117], v[102:103] op_sel:[1,1,0] op_sel_hi:[0,1,1] neg_lo:[1,0,0]
  ds_write_addtid_b32 v119 offset:3536
  v_pk_fma_f32 v[104:105], v[112:113], v[116:117], v[104:105] op_sel:[1,1,0] op_sel_hi:[0,1,1] neg_lo:[1,0,0]
  ds_write_addtid_b32 v120 offset:3808
  v_pk_fma_f32 v[106:107], v[114:115], v[116:117], v[106:107] op_sel:[1,1,0] op_sel_hi:[0,1,1] neg_lo:[1,0,0]
  ds_write_addtid_b32 v121 offset:4080
  v_pk_mul_f32 v[108:109], v[100:101], v[116:117] op_sel_hi:[1,0]
  v_cvt_pk_f16_f32 v118, v100, v101
  v_pk_mul_f32 v[110:111], v[102:103], v[116:117] op_sel_hi:[1,0]
  v_cvt_pk_f16_f32 v119, v102, v103
  v_pk_mul_f32 v[112:113], v[104:105], v[116:117] op_sel_hi:[1,0]
  v_cvt_pk_f16_f32 v120, v104, v105
  v_pk_mul_f32 v[114:115], v[106:107], v[116:117] op_sel_hi:[1,0]
  v_cvt_pk_f16_f32 v121, v106, v107
  v_pk_fma_f32 v[108:109], v[100:101], v[116:117], v[108:109] op_sel:[1,1,0] op_sel_hi:[0,1,1] neg_lo:[1,0,0]
  ds_write_addtid_b32 v118 offset:4352
  v_pk_fma_f32 v[110:111], v[102:103], v[116:117], v[110:111] op_sel:[1,1,0] op_sel_hi:[0,1,1] neg_lo:[1,0,0]
  ds_write_addtid_b32 v119 offset:4624
  v_pk_fma_f32 v[112:113], v[104:105], v[116:117], v[112:113] op_sel:[1,1,0] op_sel_hi:[0,1,1] neg_lo:[1,0,0]
  ds_write_addtid_b32 v120 offset:4896
  v_pk_fma_f32 v[114:115], v[106:107], v[116:117], v[114:115] op_sel:[1,1,0] op_sel_hi:[0,1,1] neg_lo:[1,0,0]
  ds_write_addtid_b32 v121 offset:5168
  v_pk_mul_f32 v[100:101], v[108:109], v[116:117] op_sel_hi:[1,0]
  v_cvt_pk_f16_f32 v118, v108, v109
  v_pk_mul_f32 v[102:103], v[110:111], v[116:117] op_sel_hi:[1,0]
  v_cvt_pk_f16_f32 v119, v110, v111
  v_pk_mul_f32 v[104:105], v[112:113], v[116:117] op_sel_hi:[1,0]
  v_cvt_pk_f16_f32 v120, v112, v113
  v_pk_mul_f32 v[106:107], v[114:115], v[116:117] op_sel_hi:[1,0]
  v_cvt_pk_f16_f32 v121, v114, v115
  v_pk_fma_f32 v[100:101], v[108:109], v[116:117], v[100:101] op_sel:[1,1,0] op_sel_hi:[0,1,1] neg_lo:[1,0,0]
  ds_write_addtid_b32 v118 offset:5440
  v_pk_fma_f32 v[102:103], v[110:111], v[116:117], v[102:103] op_sel:[1,1,0] op_sel_hi:[0,1,1] neg_lo:[1,0,0]
  ds_write_addtid_b32 v119 offset:5712
  v_pk_fma_f32 v[104:105], v[112:113], v[116:117], v[104:105] op_sel:[1,1,0] op_sel_hi:[0,1,1] neg_lo:[1,0,0]
  ds_write_addtid_b32 v120 offset:5984
  v_pk_fma_f32 v[106:107], v[114:115], v[116:117], v[106:107] op_sel:[1,1,0] op_sel_hi:[0,1,1] neg_lo:[1,0,0]
  ds_write_addtid_b32 v121 offset:6256
  s_waitcnt vmcnt(0)
  s_waitcnt lgkmcnt(0)
  v_mov_b32 v10, 163328
  v_mov_b32 v11, 1
  s_mov_b64 exec, 1
  ds_add_rtn_u32 v11, v10, v11 offset:0
  s_mov_b64 exec, -1
  v_pk_mul_f32 v[108:109], v[100:101], v[116:117] op_sel_hi:[1,0]
  v_cvt_pk_f16_f32 v118, v100, v101
  v_pk_mul_f32 v[110:111], v[102:103], v[116:117] op_sel_hi:[1,0]
  v_cvt_pk_f16_f32 v119, v102, v103
  v_pk_mul_f32 v[112:113], v[104:105], v[116:117] op_sel_hi:[1,0]
  v_cvt_pk_f16_f32 v120, v104, v105
  v_pk_mul_f32 v[114:115], v[106:107], v[116:117] op_sel_hi:[1,0]
  v_cvt_pk_f16_f32 v121, v106, v107
  v_pk_fma_f32 v[108:109], v[100:101], v[116:117], v[108:109] op_sel:[1,1,0] op_sel_hi:[0,1,1] neg_lo:[1,0,0]
  ds_write_addtid_b32 v118 offset:6528
  v_pk_fma_f32 v[110:111], v[102:103], v[116:117], v[110:111] op_sel:[1,1,0] op_sel_hi:[0,1,1] neg_lo:[1,0,0]
  ds_write_addtid_b32 v119 offset:6800
  v_pk_fma_f32 v[112:113], v[104:105], v[116:117], v[112:113] op_sel:[1,1,0] op_sel_hi:[0,1,1] neg_lo:[1,0,0]
  ds_write_addtid_b32 v120 offset:7072
  v_pk_fma_f32 v[114:115], v[106:107], v[116:117], v[114:115] op_sel:[1,1,0] op_sel_hi:[0,1,1] neg_lo:[1,0,0]
  ds_write_addtid_b32 v121 offset:7344
  s_waitcnt lgkmcnt(4)
  v_readfirstlane_b32 s55, v11
  s_nop 0
  s_cmp_eq_u32 s55, 3
  s_cselect_b64 exec, s[84:85], 0
  buffer_store_dwordx2 v[8:9], v3, s[4:7], 0 offen offset:384 sc1
  s_mov_b64 exec, -1
  v_cvt_pk_f16_f32 v118, v108, v109
  v_cvt_pk_f16_f32 v119, v110, v111
  v_cvt_pk_f16_f32 v120, v112, v113
  v_cvt_pk_f16_f32 v121, v114, v115
  ds_write_addtid_b32 v118 offset:7616
  ds_write_addtid_b32 v119 offset:7888
  ds_write_addtid_b32 v120 offset:8160
  ds_write_addtid_b32 v121 offset:8432
  ds_read_b128 v[60:63], v28 offset:0
  ds_read_b128 v[64:67], v28 offset:32
  ds_read_b128 v[68:71], v28 offset:64
  ds_read_b128 v[72:75], v28 offset:96
  ds_read_b128 v[76:79], v28 offset:128
  ds_read_b128 v[80:83], v28 offset:160
  ds_read_b128 v[84:87], v28 offset:192
  ds_read_b128 v[88:91], v28 offset:224
  s_load_dwordx8 s[16:23], s[46:47], s92 glc
  v_pk_mul_f32 v[100:101], v[22:23], v[32:33] op_sel_hi:[1,0]
  v_pk_mul_f32 v[102:103], v[22:23], v[30:31] op_sel_hi:[1,0]
  v_pk_fma_f32 v[100:101], v[22:23], v[32:33], v[100:101] op_sel:[1,1,0] op_sel_hi:[0,1,1] neg_lo:[1,0,0]
  v_pk_fma_f32 v[102:103], v[22:23], v[30:31], v[102:103] op_sel:[1,1,0] op_sel_hi:[0,1,1] neg_lo:[1,0,0]
  v_cvt_pk_f16_f32 v118, v22, -v23
  ds_write_addtid_b32 v118 offset:0
  v_pk_mul_f32 v[104:105], v[100:101], v[30:31] op_sel_hi:[1,0]
  v_pk_mul_f32 v[106:107], v[102:103], v[30:31] op_sel_hi:[1,0]
  v_pk_fma_f32 v[104:105], v[100:101], v[30:31], v[104:105] op_sel:[1,1,0] op_sel_hi:[0,1,1] neg_lo:[1,0,0]
  v_pk_fma_f32 v[106:107], v[102:103], v[30:31], v[106:107] op_sel:[1,1,0] op_sel_hi:[0,1,1] neg_lo:[1,0,0]
  v_cvt_pk_f16_f32 v119, v100, -v101
  ds_write_addtid_b32 v119 offset:272
  v_cvt_pk_f16_f32 v120, v102, -v103
  ds_write_addtid_b32 v120 offset:544
  v_pk_mul_f32 v[108:109], v[104:105], v[30:31] op_sel_hi:[1,0]
  v_pk_mul_f32 v[110:111], v[106:107], v[30:31] op_sel_hi:[1,0]
  v_pk_fma_f32 v[108:109], v[104:105], v[30:31], v[108:109] op_sel:[1,1,0] op_sel_hi:[0,1,1] neg_lo:[1,0,0]
  v_pk_fma_f32 v[110:111], v[106:107], v[30:31], v[110:111] op_sel:[1,1,0] op_sel_hi:[0,1,1] neg_lo:[1,0,0]
  v_cvt_pk_f16_f32 v121, v104, -v105
  ds_write_addtid_b32 v121 offset:816
  v_cvt_pk_f16_f32 v118, v106, -v107
  ds_write_addtid_b32 v118 offset:2176
  v_pk_mul_f32 v[112:113], v[108:109], v[30:31] op_sel_hi:[1,0]
  v_pk_mul_f32 v[114:115], v[110:111], v[30:31] op_sel_hi:[1,0]
  v_pk_fma_f32 v[112:113], v[108:109], v[30:31], v[112:113] op_sel:[1,1,0] op_sel_hi:[0,1,1] neg_lo:[1,0,0]
  v_pk_fma_f32 v[114:115], v[110:111], v[30:31], v[114:115] op_sel:[1,1,0] op_sel_hi:[0,1,1] neg_lo:[1,0,0]
  v_cvt_pk_f16_f32 v119, v108, -v109
  ds_write_addtid_b32 v119 offset:2448
  v_cvt_pk_f16_f32 v120, v110, -v111
  ds_write_addtid_b32 v120 offset:2720
  v_cvt_pk_f16_f32 v121, v112, -v113
  ds_write_addtid_b32 v121 offset:2992
  s_waitcnt lgkmcnt(0)
  s_cmp_lg_u64 s[16:17], s[48:49]
  s_cselect_b32 s95, 1, 0
  s_cmp_lg_u64 s[18:19], s[48:49]
  s_addc_u32 s95, s95, 0
  s_cmp_lg_u64 s[20:21], s[48:49]
  s_addc_u32 s95, s95, 0
  s_cmp_lg_u64 s[22:23], s[48:49]
  s_addc_u32 s95, s95, 0
  s_cmp_eq_u32 s95, 0
  s_cbranch_scc0 SSLOW_1
SBACK_2:
  v_pk_mul_f32 v[100:101], v[22:23], v[34:35] op_sel_hi:[1,0]
  v_pk_mul_f32 v[108:109], v[114:115], v[34:35] op_sel_hi:[1,0]
  v_pk_mul_f32 v[92:93], v[106:107], v[34:35] op_sel_hi:[1,0]
  v_pk_mul_f32 v[96:97], v[102:103], v[34:35] op_sel_hi:[1,0]
  v_pk_mul_f32 v[116:117], v[110:111], v[34:35] op_sel_hi:[1,0]
  v_pk_fma_f32 v[100:101], v[22:23], v[34:35], v[100:101] op_sel:[1,1,0] op_sel_hi:[0,1,1] neg_lo:[1,0,0]
  v_pk_fma_f32 v[108:109], v[114:115], v[34:35], v[108:109] op_sel:[1,1,0] op_sel_hi:[0,1,1] neg_lo:[1,0,0]
  v_pk_fma_f32 v[92:93], v[106:107], v[34:35], v[92:93] op_sel:[1,1,0] op_sel_hi:[0,1,1] neg_lo:[1,0,0]
  v_pk_fma_f32 v[96:97], v[102:103], v[34:35], v[96:97] op_sel:[1,1,0] op_sel_hi:[0,1,1] neg_lo:[1,0,0]
  v_pk_fma_f32 v[116:117], v[110:111], v[34:35], v[116:117] op_sel:[1,1,0] op_sel_hi:[0,1,1] neg_lo:[1,0,0]
  v_cvt_pk_f16_f32 v118, v100, -v101
  ds_write_addtid_b32 v118 offset:1088
  ds_write_addtid_b32 v118 offset:1360
  buffer_load_dwordx4 a[0:3], v12, s[4:7], s76 offen offset:0 sc1
  v_cvt_pk_f16_f32 v119, v96, -v97
  ds_write_addtid_b32 v119 offset:1632
  v_cvt_pk_f16_f32 v120, v92, -v93
  ds_write_addtid_b32 v120 offset:1904
  ds_write_addtid_b32 v120 offset:3264
  ds_write_addtid_b32 v120 offset:3536
  buffer_load_dwordx4 a[4:7], v12, s[4:7], s76 offen offset:2048 sc1
  v_add_u32 v12, 4096, v12
  v_cvt_pk_f16_f32 v121, v116, -v117
  ds_write_addtid_b32 v121 offset:3808
  v_cvt_pk_f16_f32 v118, v108, -v109
  ds_write_addtid_b32 v118 offset:4080
  v_pk_mul_f32 v[104:105], v[100:101], v[34:35] op_sel_hi:[1,0]
  v_pk_mul_f32 v[112:113], v[108:109], v[34:35] op_sel_hi:[1,0]
  v_pk_mul_f32 v[94:95], v[92:93], v[34:35] op_sel_hi:[1,0]
  v_pk_fma_f32 v[104:105], v[100:101], v[34:35], v[104:105] op_sel:[1,1,0] op_sel_hi:[0,1,1] neg_lo:[1,0,0]
  v_pk_fma_f32 v[112:113], v[108:109], v[34:35], v[112:113] op_sel:[1,1,0] op_sel_hi:[0,1,1] neg_lo:[1,0,0]
  v_pk_fma_f32 v[94:95], v[92:93], v[34:35], v[94:95] op_sel:[1,1,0] op_sel_hi:[0,1,1] neg_lo:[1,0,0]
  v_cvt_pk_f16_f32 v119, v104, -v105
  ds_write_addtid_b32 v119 offset:4352
  buffer_load_dwordx4 a[8:11], v12, s[4:7], s76 offen offset:0 sc1
  v_cvt_pk_f16_f32 v120, v94, -v95
  ds_write_addtid_b32 v120 offset:4624
  v_cvt_pk_f16_f32 v121, v112, -v113
  ds_write_addtid_b32 v121 offset:4896
  v_pk_mul_f32 v[100:101], v[104:105], v[34:35] op_sel_hi:[1,0]
  v_pk_mul_f32 v[108:109], v[112:113], v[34:35] op_sel_hi:[1,0]
  v_pk_mul_f32 v[92:93], v[94:95], v[34:35] op_sel_hi:[1,0]
  v_pk_fma_f32 v[100:101], v[104:105], v[34:35], v[100:101] op_sel:[1,1,0] op_sel_hi:[0,1,1] neg_lo:[1,0,0]
  v_pk_fma_f32 v[108:109], v[112:113], v[34:35], v[108:109] op_sel:[1,1,0] op_sel_hi:[0,1,1] neg_lo:[1,0,0]
  v_pk_fma_f32 v[92:93], v[94:95], v[34:35], v[92:93] op_sel:[1,1,0] op_sel_hi:[0,1,1] neg_lo:[1,0,0]
  v_cvt_pk_f16_f32 v118, v100, -v101
  ds_write_addtid_b32 v118 offset:5440
  buffer_load_dwordx4 a[12:15], v12, s[4:7], s76 offen offset:2048 sc1
  v_add_u32 v12, 4096, v12
  v_cvt_pk_f16_f32 v119, v92, -v93
  ds_write_addtid_b32 v119 offset:5712
  v_cvt_pk_f16_f32 v120, v108, -v109
  ds_write_addtid_b32 v120 offset:5984
  v_pk_mul_f32 v[104:105], v[100:101], v[34:35] op_sel_hi:[1,0]
  v_pk_mul_f32 v[112:113], v[108:109], v[34:35] op_sel_hi:[1,0]
  v_pk_fma_f32 v[104:105], v[100:101], v[34:35], v[104:105] op_sel:[1,1,0] op_sel_hi:[0,1,1] neg_lo:[1,0,0]
  v_pk_fma_f32 v[112:113], v[108:109], v[34:35], v[112:113] op_sel:[1,1,0] op_sel_hi:[0,1,1] neg_lo:[1,0,0]
  v_cvt_pk_f16_f32 v121, v104, -v105
  ds_write_addtid_b32 v121 offset:5168
  v_cvt_pk_f16_f32 v118, v112, -v113
  ds_write_addtid_b32 v118 offset:6528
  buffer_load_dwordx4 a[16:19], v12, s[4:7], s76 offen offset:0 sc1
  v_pk_mul_f32 v[100:101], v[104:105], v[34:35] op_sel_hi:[1,0]
  v_pk_mul_f32 v[108:109], v[112:113], v[34:35] op_sel_hi:[1,0]
  v_pk_fma_f32 v[100:101], v[104:105], v[34:35], v[100:101] op_sel:[1,1,0] op_sel_hi:[0,1,1] neg_lo:[1,0,0]
  v_pk_fma_f32 v[108:109], v[112:113], v[34:35], v[108:109] op_sel:[1,1,0] op_sel_hi:[0,1,1] neg_lo:[1,0,0]
  v_cvt_pk_f16_f32 v119, v100, -v101
  ds_write_addtid_b32 v119 offset:6256
  v_cvt_pk_f16_f32 v120, v108, -v109
  ds_write_addtid_b32 v120 offset:7616
  v_pk_mul_f32 v[104:105], v[100:101], v[34:35] op_sel_hi:[1,0]
  v_pk_mul_f32 v[112:113], v[108:109], v[34:35] op_sel_hi:[1,0]
  v_pk_fma_f32 v[104:105], v[100:101], v[34:35], v[104:105] op_sel:[1,1,0] op_sel_hi:[0,1,1] neg_lo:[1,0,0]
  v_pk_fma_f32 v[112:113], v[108:109], v[34:35], v[112:113] op_sel:[1,1,0] op_sel_hi:[0,1,1] neg_lo:[1,0,0]
  v_cvt_pk_f16_f32 v121, v104, -v105
  ds_write_addtid_b32 v121 offset:6800
  buffer_load_dwordx4 a[20:23], v12, s[4:7], s76 offen offset:2048 sc1
  v_add_u32 v12, 4096, v12
  v_cvt_pk_f16_f32 v118, v112, -v113
  ds_write_addtid_b32 v118 offset:7072
  v_pk_mul_f32 v[100:101], v[104:105], v[34:35] op_sel_hi:[1,0]
  v_pk_mul_f32 v[108:109], v[112:113], v[34:35] op_sel_hi:[1,0]
  v_pk_fma_f32 v[100:101], v[104:105], v[34:35], v[100:101] op_sel:[1,1,0] op_sel_hi:[0,1,1] neg_lo:[1,0,0]
  v_pk_fma_f32 v[108:109], v[112:113], v[34:35], v[108:109] op_sel:[1,1,0] op_sel_hi:[0,1,1] neg_lo:[1,0,0]
  v_cvt_pk_f16_f32 v119, v100, -v101
  ds_write_addtid_b32 v119 offset:7888
  v_cvt_pk_f16_f32 v120, v108, -v109
  ds_write_addtid_b32 v120 offset:8160
  ds_read_b128 v[92:95], v28 offset:0
  ds_read_b128 v[96:99], v28 offset:32
  ds_read_b128 v[100:103], v28 offset:64
  ds_read_b128 v[104:107], v28 offset:96
  ds_read_b128 v[108:111], v28 offset:128
  ds_read_b128 v[112:115], v28 offset:160
  ds_read_b128 v[116:119], v28 offset:192
  ds_read_b128 v[120:123], v28 offset:224
  s_waitcnt lgkmcnt(7)
  v_mfma_f32_32x32x16_f16 v[44:59], v[92:95], v[60:63], 0
  buffer_load_dwordx4 a[24:27], v12, s[4:7], s76 offen offset:0 sc1
  s_waitcnt lgkmcnt(6)
  v_mfma_f32_32x32x16_f16 v[44:59], v[96:99], v[64:67], v[44:59]
  s_waitcnt lgkmcnt(5)
  v_mfma_f32_32x32x16_f16 v[44:59], v[100:103], v[68:71], v[44:59]
  s_waitcnt lgkmcnt(4)
  v_mfma_f32_32x32x16_f16 v[44:59], v[104:107], v[72:75], v[44:59]
  buffer_load_dwordx4 a[28:31], v12, s[4:7], s76 offen offset:2048 sc1
  v_add_u32 v12, 4096, v12
  s_waitcnt lgkmcnt(3)
  v_mfma_f32_32x32x16_f16 v[44:59], v[108:111], v[76:79], v[44:59]
  s_waitcnt lgkmcnt(2)
  v_mfma_f32_32x32x16_f16 v[44:59], v[112:115], v[80:83], v[44:59]
  s_waitcnt lgkmcnt(1)
  v_mfma_f32_32x32x16_f16 v[44:59], v[116:119], v[84:87], v[44:59]
  buffer_load_dwordx4 a[32:35], v12, s[4:7], s76 offen offset:0 sc1
  s_waitcnt lgkmcnt(0)
  v_mfma_f32_32x32x16_f16 v[44:59], v[120:123], v[88:91], v[44:59]
  s_mov_b64 exec, s[84:85]
  buffer_load_dwordx2 v[124:125], v6, s[4:7], 0 offen offset:384 sc1
  s_mov_b64 exec, -1
  buffer_load_dwordx4 a[36:39], v12, s[4:7], s76 offen offset:2048 sc1
  v_add_u32 v12, 4096, v12
  buffer_load_dwordx4 a[40:43], v12, s[4:7], s76 offen offset:0 sc1
  buffer_load_dwordx4 a[44:47], v12, s[4:7], s76 offen offset:2048 sc1
  v_add_u32 v12, 4096, v12
  buffer_load_dwordx4 a[48:51], v12, s[4:7], s76 offen offset:0 sc1
  buffer_load_dwordx4 a[52:55], v12, s[4:7], s76 offen offset:2048 sc1
  v_add_u32 v12, 4096, v12
  buffer_load_dwordx4 a[56:59], v12, s[4:7], s76 offen offset:0 sc1
  s_lshl_b32 s55, s52, 2
  s_add_u32 s55, s55, 163392
  v_mov_b32 v10, s55
  s_mov_b32 s96, 400000
LB_3:
  ds_read_b32 v11, v10 offset:0
  s_waitcnt lgkmcnt(0)
  v_readfirstlane_b32 s55, v11
  s_nop 0
  s_cmp_ge_u32 s55, 2
  s_cbranch_scc1 LBD_4
  s_sub_u32 s96, s96, 1
  s_cmp_lg_u32 s96, 0
  s_cbranch_scc1 LB_3
  s_or_b32 s97, s97, 1024
LBD_4:
  s_mul_i32 s55, s52, 3072
  s_add_u32 s55, s55, 35840
  v_add_u32 v96, s55, v2
  ds_read_b128 v[100:103], v96
  ds_read_b128 v[104:107], v96 offset:1024
  s_waitcnt lgkmcnt(0)
  v_fma_mix_f32 v44, v100, 1.0, v44 op_sel:[0,0,0] op_sel_hi:[1,0,0]
  v_fma_mix_f32 v45, v100, 1.0, v45 op_sel:[1,0,0] op_sel_hi:[1,0,0]
  v_fma_mix_f32 v46, v101, 1.0, v46 op_sel:[0,0,0] op_sel_hi:[1,0,0]
  v_fma_mix_f32 v47, v101, 1.0, v47 op_sel:[1,0,0] op_sel_hi:[1,0,0]
  v_fma_mix_f32 v48, v102, 1.0, v48 op_sel:[0,0,0] op_sel_hi:[1,0,0]
  v_fma_mix_f32 v49, v102, 1.0, v49 op_sel:[1,0,0] op_sel_hi:[1,0,0]
  v_fma_mix_f32 v50, v103, 1.0, v50 op_sel:[0,0,0] op_sel_hi:[1,0,0]
  v_fma_mix_f32 v51, v103, 1.0, v51 op_sel:[1,0,0] op_sel_hi:[1,0,0]
  v_fma_mix_f32 v52, v104, 1.0, v52 op_sel:[0,0,0] op_sel_hi:[1,0,0]
  v_fma_mix_f32 v53, v104, 1.0, v53 op_sel:[1,0,0] op_sel_hi:[1,0,0]
  v_fma_mix_f32 v54, v105, 1.0, v54 op_sel:[0,0,0] op_sel_hi:[1,0,0]
  v_fma_mix_f32 v55, v105, 1.0, v55 op_sel:[1,0,0] op_sel_hi:[1,0,0]
  v_fma_mix_f32 v56, v106, 1.0, v56 op_sel:[0,0,0] op_sel_hi:[1,0,0]
  v_fma_mix_f32 v57, v106, 1.0, v57 op_sel:[1,0,0] op_sel_hi:[1,0,0]
  v_fma_mix_f32 v58, v107, 1.0, v58 op_sel:[0,0,0] op_sel_hi:[1,0,0]
  v_mov_b32 v59, v26
  s_mul_i32 s55, s54, 10368
  s_add_u32 s55, s55, s72
  v_add_u32 v92, s55, v2
  ds_write_b128 v92, v[44:47] offset:0
  ds_write_b128 v92, v[48:51] offset:1024
  ds_write_b128 v92, v[52:55] offset:4160
  ds_write_b128 v92, v[56:59] offset:5184
  s_waitcnt lgkmcnt(0)
  v_mov_b32 v10, s79
  v_mov_b32 v11, 1
  s_mov_b64 exec, 1
  ds_add_rtn_u32 v11, v10, v11 offset:16
  s_mov_b64 exec, -1
  s_waitcnt lgkmcnt(0)
  v_readfirstlane_b32 s55, v11
  s_nop 0
  s_cmp_ge_u32 s55, 1
  s_cbranch_scc1 LBD_6
  s_mov_b32 s96, 400000
LB_5:
  ds_read_b32 v11, v10 offset:16
  s_waitcnt lgkmcnt(0)
  v_readfirstlane_b32 s55, v11
  s_nop 0
  s_cmp_ge_u32 s55, 2
  s_cbranch_scc1 LBD_6
  s_sub_u32 s96, s96, 1
  s_cmp_lg_u32 s96, 0
  s_cbranch_scc1 LB_5
  s_or_b32 s97, s97, 1024
LBD_6:
  s_xor_b32 s55, s54, 1
  s_mul_i32 s55, s55, 10368
  s_add_u32 s55, s55, s72
  v_add_u32 v92, s55, v2
  ds_read_b128 v[96:99], v92 offset:0
  ds_read_b128 v[100:103], v92 offset:1024
  ds_read_b128 v[104:107], v92 offset:4160
  ds_read_b128 v[108:111], v92 offset:5184
  s_waitcnt lgkmcnt(0)
  v_max_i32 v93, v26, v111
  v_sub_u32 v94, v26, v93
  v_sub_u32 v95, v111, v93
  v_add_u32 v94, 6, v94
  v_add_u32 v95, 6, v95
  v_ldexp_f32 v94, 1.0, v94
  v_ldexp_f32 v112, 1.0, v95
  v_subrev_u32 v93, 6, v93
  v_ldexp_f32 v36, v27, v93
  v_mov_b32 v37, s35
  v_mul_f32 v44, v44, v94
  v_mul_f32 v45, v45, v94
  v_mul_f32 v46, v46, v94
  v_mul_f32 v47, v47, v94
  v_mul_f32 v48, v48, v94
  v_mul_f32 v49, v49, v94
  v_mul_f32 v50, v50, v94
  v_mul_f32 v51, v51, v94
  v_mul_f32 v52, v52, v94
  v_mul_f32 v53, v53, v94
  v_mul_f32 v54, v54, v94
  v_mul_f32 v55, v55, v94
  v_mul_f32 v56, v56, v94
  v_mul_f32 v57, v57, v94
  v_mul_f32 v58, v58, v94
  v_fma_f32 v44, v96, v112, v44
  v_fma_f32 v45, v97, v112, v45
  v_fma_f32 v46, v98, v112, v46
  v_fma_f32 v47, v99, v112, v47
  v_fma_f32 v48, v100, v112, v48
  v_fma_f32 v49, v101, v112, v49
  v_fma_f32 v50, v102, v112, v50
  v_fma_f32 v51, v103, v112, v51
  v_fma_f32 v52, v104, v112, v52
  v_fma_f32 v53, v105, v112, v53
  v_fma_f32 v54, v106, v112, v54
  v_fma_f32 v55, v107, v112, v55
  v_fma_f32 v56, v108, v112, v56
  v_fma_f32 v57, v109, v112, v57
  v_fma_f32 v58, v110, v112, v58
  buffer_load_dwordx4 a[60:63], v12, s[4:7], s76 offen offset:2048 sc1
  v_add_u32 v12, 4096, v12
  buffer_load_dwordx4 a[64:67], v12, s[4:7], s76 offen offset:0 sc1
  buffer_load_dwordx4 a[68:71], v12, s[4:7], s76 offen offset:2048 sc1
  v_add_u32 v12, 4096, v12
  buffer_load_dwordx4 a[72:75], v12, s[4:7], s76 offen offset:0 sc1
  s_waitcnt vmcnt(10)
  s_mov_b64 exec, s[84:85]
  v_cmp_ne_u64 vcc, v[124:125], v[8:9]
  s_cbranch_vccnz PSLOW_7
PBACK_8:
  s_mov_b64 exec, -1
  s_lshl_b32 s56, s54, 5
  s_add_u32 s55, s74, s56
  s_add_u32 s55, s55, 4194304
  v_lshlrev_b32 v43, 6, v0
  s_add_u32 m0, s78, 512
  s_nop 0
  buffer_load_dwordx4 v43, s[4:7], s55 offen sc1 lds
  s_add_u32 m0, s78, 2032
  s_nop 0
  buffer_load_dwordx4 v43, s[4:7], s55 offen offset:16 sc1 lds
  v_and_b32 v92, 1, v0
  v_cmp_eq_u32 vcc, 1, v92
  s_nop 1
  v_cndmask_b32 v93, v55, v56, vcc
  v_cndmask_b32 v94, v57, v58, vcc
  v_cvt_pk_f16_f32 v96, v51, v50
  v_cvt_pk_f16_f32 v97, v49, v48
  v_cvt_pk_f16_f32 v98, v47, v46
  v_cvt_pk_f16_f32 v99, v45, v44
  v_cvt_pk_f16_f32 v100, v54, v54
  v_cvt_pk_f16_f32 v101, v53, v53
  v_cvt_pk_f16_f32 v102, v53, v52
  v_cvt_pk_f16_f32 v103, v52, v52
  v_cvt_pk_f16_f32 v104, v56, v56
  v_cvt_pk_f16_f32 v105, v56, v93
  v_cvt_pk_f16_f32 v106, v55, v55
  v_cvt_pk_f16_f32 v107, v55, v55
  v_cvt_pk_f16_f32 v108, v58, v58
  v_cvt_pk_f16_f32 v109, v58, v94
  v_cvt_pk_f16_f32 v110, v57, v57
  v_cvt_pk_f16_f32 v111, v57, v57
  s_cmp_eq_u32 s54, 1
  s_cselect_b64 vcc, -1, 0
  v_cndmask_b32 v112, 0, v100, vcc
  v_cndmask_b32 v113, 0, v101, vcc
  v_cndmask_b32 v96, v96, v104, vcc
  v_cndmask_b32 v97, v97, v105, vcc
  v_cndmask_b32 v98, v98, v106, vcc
  v_cndmask_b32 v99, v99, v107, vcc
  v_cndmask_b32 v100, v100, v108, vcc
  v_cndmask_b32 v101, v101, v109, vcc
  v_cndmask_b32 v102, v102, v110, vcc
  v_cndmask_b32 v103, v103, v111, vcc
  s_lshl_b32 s56, s54, 11
  s_sub_u32 s55, s72, s56
  s_add_u32 s55, s55, 3056
  v_sub_u32 v92, s55, v2
  v_mov_b32_dpp v107, v112 wave_ror:1 row_mask:0xf bank_mask:0xf
  v_mov_b32_dpp v114, v113 wave_ror:1 row_mask:0xf bank_mask:0xf
  v_mov_b32 v104, v97
  v_mov_b32 v105, v98
  v_mov_b32 v106, v99
  v_mov_b32_dpp v107, v96 wave_shr:1 row_mask:0xf bank_mask:0xf
  v_mov_b32_dpp v114, v97 wave_shr:1 row_mask:0xf bank_mask:0xf
  v_alignbit_b32 v108, v97, v96, 16
  v_alignbit_b32 v109, v98, v97, 16
  v_alignbit_b32 v110, v99, v98, 16
  v_alignbit_b32 v111, v107, v99, 16
  v_alignbit_b32 v116, v98, v97, 16
  v_alignbit_b32 v117, v99, v98, 16
  v_alignbit_b32 v118, v107, v99, 16
  v_alignbit_b32 v119, v114, v107, 16
  ds_write_b128 v92, v[96:99] offset:1024
  ds_write_b128 v92, v[108:111] offset:5184
  ds_write_b128 v92, v[104:107] offset:9344
  ds_write_b128 v92, v[116:119] offset:13504
  v_mov_b32_dpp v107, v96 wave_ror:1 row_mask:0xf bank_mask:0xf
  v_mov_b32_dpp v114, v97 wave_ror:1 row_mask:0xf bank_mask:0xf
  v_mov_b32 v104, v101
  v_mov_b32 v105, v102
  v_mov_b32 v106, v103
  v_mov_b32_dpp v107, v100 wave_shr:1 row_mask:0xf bank_mask:0xf
  v_mov_b32_dpp v114, v101 wave_shr:1 row_mask:0xf bank_mask:0xf
  v_alignbit_b32 v108, v101, v100, 16
  v_alignbit_b32 v109, v102, v101, 16
  v_alignbit_b32 v110, v103, v102, 16
  v_alignbit_b32 v111, v107, v103, 16
  v_alignbit_b32 v116, v102, v101, 16
  v_alignbit_b32 v117, v103, v102, 16
  v_alignbit_b32 v118, v107, v103, 16
  v_alignbit_b32 v119, v114, v107, 16
  ds_write_b128 v92, v[100:103] offset:0
  ds_write_b128 v92, v[108:111] offset:4160
  ds_write_b128 v92, v[104:107] offset:8320
  ds_write_b128 v92, v[116:119] offset:12480
  v_mov_b32 v96, 0
  v_mov_b32 v97, 0
  v_mov_b32 v98, 0
  v_mov_b32 v99, 0
  v_bfe_u32 v92, v0, 2, 2
  v_mul_u32_u24 v92, 4160, v92
  v_lshl_add_u32 v92, v29, 4, v92
  v_add_u32 v92, s72, v92
  ds_write_b128 v92, v[96:99] offset:4096
  ds_write_b128 v40, v[96:99]
  buffer_load_dwordx4 a[76:79], v12, s[4:7], s76 offen offset:2048 sc1
  v_add_u32 v12, 4096, v12
  buffer_load_dwordx4 a[80:83], v12, s[4:7], s76 offen offset:0 sc1
  buffer_load_dwordx4 a[84:87], v12, s[4:7], s76 offen offset:2048 sc1
  v_add_u32 v12, 4096, v12
  buffer_load_dwordx4 a[88:91], v12, s[4:7], s76 offen offset:0 sc1
  buffer_load_dwordx4 a[92:95], v12, s[4:7], s76 offen offset:2048 sc1
  v_add_u32 v12, 4096, v12
  buffer_load_dwordx4 a[96:99], v12, s[4:7], s76 offen offset:0 sc1
  buffer_load_dwordx4 a[100:103], v12, s[4:7], s76 offen offset:2048 sc1
  v_add_u32 v12, 4096, v12
  buffer_load_dwordx4 a[104:107], v12, s[4:7], s76 offen offset:0 sc1
  s_waitcnt vmcnt(8)
  s_waitcnt lgkmcnt(0)
  v_mov_b32 v10, s79
  v_mov_b32 v11, 1
  s_mov_b64 exec, 1
  ds_add_rtn_u32 v11, v10, v11 offset:24
  s_mov_b64 exec, -1
  s_waitcnt lgkmcnt(0)
  v_readfirstlane_b32 s55, v11
  s_nop 0
  s_cmp_ge_u32 s55, 1
  s_cbranch_scc1 LBD_10
  s_mov_b32 s96, 400000
LB_9:
  ds_read_b32 v11, v10 offset:24
  s_waitcnt lgkmcnt(0)
  v_readfirstlane_b32 s55, v11
  s_nop 0
  s_cmp_ge_u32 s55, 2
  s_cbranch_scc1 LBD_10
  s_sub_u32 s96, s96, 1
  s_cmp_lg_u32 s96, 0
  s_cbranch_scc1 LB_9
  s_or_b32 s97, s97, 1024
LBD_10:
  ds_read_b64 v[60:61], v38 offset:4032
  ds_read_b64 v[62:63], v38 offset:4040
  ds_read_b128 v[76:79], v39 offset:512
  ds_read_b128 v[80:83], v39 offset:768
  ds_read_b128 v[84:87], v39 offset:1024
  ds_read_b128 v[88:91], v39 offset:1280
  ds_read_b64 v[64:65], v38 offset:3008
  ds_read_b64 v[66:67], v38 offset:3016
  ds_read_b64 v[68:69], v38 offset:1984
  ds_read_b64 v[70:71], v38 offset:1992
  ds_read_b64 v[72:73], v38 offset:960
  ds_read_b64 v[74:75], v38 offset:968
  s_waitcnt lgkmcnt(8)
  v_mfma_f32_16x16x32_f16 v[44:47], v[60:63], v[76:79], 0
  ds_read_b64 v[92:93], v38 offset:3968
  ds_read_b64 v[94:95], v38 offset:3976
  v_mfma_f32_16x16x32_f16 v[48:51], v[60:63], v[80:83], 0
  ds_read_b128 v[108:111], v39 offset:496
  s_waitcnt lgkmcnt(9)
  v_mfma_f32_16x16x32_f16 v[52:55], v[60:63], v[84:87], 0
  ds_read_b128 v[112:115], v39 offset:752
  v_mfma_f32_16x16x32_f16 v[56:59], v[60:63], v[88:91], 0
  ds_read_b128 v[116:119], v39 offset:1008
  s_waitcnt lgkmcnt(7)
  v_mfma_f32_16x16x32_f16 v[48:51], v[64:67], v[76:79], v[48:51]
  ds_read_b128 v[120:123], v39 offset:1264
  v_mfma_f32_16x16x32_f16 v[52:55], v[64:67], v[80:83], v[52:55]
  ds_read_b64 v[96:97], v38 offset:2944
  ds_read_b64 v[98:99], v38 offset:2952
  v_mfma_f32_16x16x32_f16 v[56:59], v[64:67], v[84:87], v[56:59]
  ds_read_b64 v[100:101], v38 offset:1920
  ds_read_b64 v[102:103], v38 offset:1928
  v_mfma_f32_16x16x32_f16 v[52:55], v[68:71], v[76:79], v[52:55]
  ds_read_b64 v[104:105], v38 offset:896
  ds_read_b64 v[106:107], v38 offset:904
  v_mfma_f32_16x16x32_f16 v[56:59], v[68:71], v[80:83], v[56:59]
  s_waitcnt lgkmcnt(12)
  v_mfma_f32_16x16x32_f16 v[56:59], v[72:75], v[76:79], v[56:59]
  buffer_load_dwordx4 a[108:111], v12, s[4:7], s76 offen offset:2048 sc1
  v_add_u32 v12, 4096, v12
  s_waitcnt lgkmcnt(8)
  v_mfma_f32_16x16x32_f16 v[44:47], v[92:95], v[108:111], v[44:47]
  ds_read_b64 v[60:61], v38 offset:3904
  ds_read_b64 v[62:63], v38 offset:3912
  v_mfma_f32_16x16x32_f16 v[48:51], v[92:95], v[112:115], v[48:51]
  ds_read_b128 v[76:79], v39 offset:480
  s_waitcnt lgkmcnt(9)
  v_mfma_f32_16x16x32_f16 v[52:55], v[92:95], v[116:119], v[52:55]
  ds_read_b128 v[80:83], v39 offset:736
  v_mfma_f32_16x16x32_f16 v[56:59], v[92:95], v[120:123], v[56:59]
  ds_read_b128 v[84:87], v39 offset:992
  s_waitcnt lgkmcnt(7)
  v_mfma_f32_16x16x32_f16 v[48:51], v[96:99], v[108:111], v[48:51]
  ds_read_b128 v[88:91], v39 offset:1248
  v_mfma_f32_16x16x32_f16 v[52:55], v[96:99], v[112:115], v[52:55]
  ds_read_b64 v[64:65], v38 offset:2880
  ds_read_b64 v[66:67], v38 offset:2888
  v_mfma_f32_16x16x32_f16 v[56:59], v[96:99], v[116:119], v[56:59]
  ds_read_b64 v[68:69], v38 offset:1856
  ds_read_b64 v[70:71], v38 offset:1864
  v_mfma_f32_16x16x32_f16 v[52:55], v[100:103], v[108:111], v[52:55]
  ds_read_b64 v[72:73], v38 offset:832
  ds_read_b64 v[74:75], v38 offset:840
  v_mfma_f32_16x16x32_f16 v[56:59], v[100:103], v[112:115], v[56:59]
  s_waitcnt lgkmcnt(12)
  v_mfma_f32_16x16x32_f16 v[56:59], v[104:107], v[108:111], v[56:59]
  s_waitcnt lgkmcnt(8)
  v_mfma_f32_16x16x32_f16 v[44:47], v[60:63], v[76:79], v[44:47]
  ds_read_b64 v[92:93], v38 offset:3840
  ds_read_b64 v[94:95], v38 offset:3848
  v_mfma_f32_16x16x32_f16 v[48:51], v[60:63], v[80:83], v[48:51]
  ds_read_b128 v[108:111], v39 offset:464
  s_waitcnt lgkmcnt(9)
  v_mfma_f32_16x16x32_f16 v[52:55], v[60:63], v[84:87], v[52:55]
  ds_read_b128 v[112:115], v39 offset:720
  v_mfma_f32_16x16x32_f16 v[56:59], v[60:63], v[88:91], v[56:59]
  ds_read_b128 v[116:119], v39 offset:976
  s_waitcnt lgkmcnt(7)
  v_mfma_f32_16x16x32_f16 v[48:51], v[64:67], v[76:79], v[48:51]
  ds_read_b128 v[120:123], v39 offset:1232
  v_mfma_f32_16x16x32_f16 v[52:55], v[64:67], v[80:83], v[52:55]
  ds_read_b64 v[96:97], v38 offset:2816
  ds_read_b64 v[98:99], v38 offset:2824
  v_mfma_f32_16x16x32_f16 v[56:59], v[64:67], v[84:87], v[56:59]
  ds_read_b64 v[100:101], v38 offset:1792
  ds_read_b64 v[102:103], v38 offset:1800
  v_mfma_f32_16x16x32_f16 v[52:55], v[68:71], v[76:79], v[52:55]
  ds_read_b64 v[104:105], v38 offset:768
  ds_read_b64 v[106:107], v38 offset:776
  v_mfma_f32_16x16x32_f16 v[56:59], v[68:71], v[80:83], v[56:59]
  s_waitcnt lgkmcnt(12)
  v_mfma_f32_16x16x32_f16 v[56:59], v[72:75], v[76:79], v[56:59]
  s_waitcnt lgkmcnt(8)
  v_mfma_f32_16x16x32_f16 v[44:47], v[92:95], v[108:111], v[44:47]
  ds_read_b64 v[60:61], v38 offset:3776
  ds_read_b64 v[62:63], v38 offset:3784
  v_mfma_f32_16x16x32_f16 v[48:51], v[92:95], v[112:115], v[48:51]
  ds_read_b128 v[76:79], v39 offset:448
  s_waitcnt lgkmcnt(9)
  v_mfma_f32_16x16x32_f16 v[52:55], v[92:95], v[116:119], v[52:55]
  ds_read_b128 v[80:83], v39 offset:704
  v_mfma_f32_16x16x32_f16 v[56:59], v[92:95], v[120:123], v[56:59]
  ds_read_b128 v[84:87], v39 offset:960
  s_waitcnt lgkmcnt(7)
  v_mfma_f32_16x16x32_f16 v[48:51], v[96:99], v[108:111], v[48:51]
  ds_read_b128 v[88:91], v39 offset:1216
  v_mfma_f32_16x16x32_f16 v[52:55], v[96:99], v[112:115], v[52:55]
  ds_read_b64 v[64:65], v38 offset:2752
  ds_read_b64 v[66:67], v38 offset:2760
  v_mfma_f32_16x16x32_f16 v[56:59], v[96:99], v[116:119], v[56:59]
  ds_read_b64 v[68:69], v38 offset:1728
  ds_read_b64 v[70:71], v38 offset:1736
  v_mfma_f32_16x16x32_f16 v[52:55], v[100:103], v[108:111], v[52:55]
  ds_read_b64 v[72:73], v38 offset:704
  ds_read_b64 v[74:75], v38 offset:712
  v_mfma_f32_16x16x32_f16 v[56:59], v[100:103], v[112:115], v[56:59]
  s_waitcnt lgkmcnt(12)
  v_mfma_f32_16x16x32_f16 v[56:59], v[104:107], v[108:111], v[56:59]
  s_waitcnt lgkmcnt(8)
  v_mfma_f32_16x16x32_f16 v[44:47], v[60:63], v[76:79], v[44:47]
  ds_read_b64 v[92:93], v38 offset:3712
  ds_read_b64 v[94:95], v38 offset:3720
  v_mfma_f32_16x16x32_f16 v[48:51], v[60:63], v[80:83], v[48:51]
  ds_read_b128 v[108:111], v39 offset:432
  s_waitcnt lgkmcnt(9)
  v_mfma_f32_16x16x32_f16 v[52:55], v[60:63], v[84:87], v[52:55]
  ds_read_b128 v[112:115], v39 offset:688
  v_mfma_f32_16x16x32_f16 v[56:59], v[60:63], v[88:91], v[56:59]
  ds_read_b128 v[116:119], v39 offset:944
  s_waitcnt lgkmcnt(7)
  v_mfma_f32_16x16x32_f16 v[48:51], v[64:67], v[76:79], v[48:51]
  ds_read_b128 v[120:123], v39 offset:1200
  v_mfma_f32_16x16x32_f16 v[52:55], v[64:67], v[80:83], v[52:55]
  ds_read_b64 v[96:97], v38 offset:2688
  ds_read_b64 v[98:99], v38 offset:2696
  v_mfma_f32_16x16x32_f16 v[56:59], v[64:67], v[84:87], v[56:59]
  ds_read_b64 v[100:101], v38 offset:1664
  ds_read_b64 v[102:103], v38 offset:1672
  v_mfma_f32_16x16x32_f16 v[52:55], v[68:71], v[76:79], v[52:55]
  ds_read_b64 v[104:105], v38 offset:640
  ds_read_b64 v[106:107], v38 offset:648
  v_mfma_f32_16x16x32_f16 v[56:59], v[68:71], v[80:83], v[56:59]
  s_waitcnt lgkmcnt(12)
  v_mfma_f32_16x16x32_f16 v[56:59], v[72:75], v[76:79], v[56:59]
  s_waitcnt lgkmcnt(8)
  v_mfma_f32_16x16x32_f16 v[44:47], v[92:95], v[108:111], v[44:47]
  ds_read_b64 v[60:61], v38 offset:3648
  ds_read_b64 v[62:63], v38 offset:3656
  v_mfma_f32_16x16x32_f16 v[48:51], v[92:95], v[112:115], v[48:51]
  ds_read_b128 v[76:79], v39 offset:416
  s_waitcnt lgkmcnt(9)
  v_mfma_f32_16x16x32_f16 v[52:55], v[92:95], v[116:119], v[52:55]
  ds_read_b128 v[80:83], v39 offset:672
  v_mfma_f32_16x16x32_f16 v[56:59], v[92:95], v[120:123], v[56:59]
  ds_read_b128 v[84:87], v39 offset:928
  s_waitcnt lgkmcnt(7)
  v_mfma_f32_16x16x32_f16 v[48:51], v[96:99], v[108:111], v[48:51]
  ds_read_b128 v[88:91], v39 offset:1184
  v_mfma_f32_16x16x32_f16 v[52:55], v[96:99], v[112:115], v[52:55]
  ds_read_b64 v[64:65], v38 offset:2624
  ds_read_b64 v[66:67], v38 offset:2632
  v_mfma_f32_16x16x32_f16 v[56:59], v[96:99], v[116:119], v[56:59]
  ds_read_b64 v[68:69], v38 offset:1600
  ds_read_b64 v[70:71], v38 offset:1608
  v_mfma_f32_16x16x32_f16 v[52:55], v[100:103], v[108:111], v[52:55]
  ds_read_b64 v[72:73], v38 offset:576
  ds_read_b64 v[74:75], v38 offset:584
  v_mfma_f32_16x16x32_f16 v[56:59], v[100:103], v[112:115], v[56:59]
  s_waitcnt lgkmcnt(12)
  v_mfma_f32_16x16x32_f16 v[56:59], v[104:107], v[108:111], v[56:59]
  s_waitcnt lgkmcnt(8)
  v_mfma_f32_16x16x32_f16 v[44:47], v[60:63], v[76:79], v[44:47]
  ds_read_b64 v[92:93], v38 offset:3584
  ds_read_b64 v[94:95], v38 offset:3592
  v_mfma_f32_16x16x32_f16 v[48:51], v[60:63], v[80:83], v[48:51]
  ds_read_b128 v[108:111], v39 offset:400
  s_waitcnt lgkmcnt(9)
  v_mfma_f32_16x16x32_f16 v[52:55], v[60:63], v[84:87], v[52:55]
  ds_read_b128 v[112:115], v39 offset:656
  v_mfma_f32_16x16x32_f16 v[56:59], v[60:63], v[88:91], v[56:59]
  ds_read_b128 v[116:119], v39 offset:912
  s_waitcnt lgkmcnt(7)
  v_mfma_f32_16x16x32_f16 v[48:51], v[64:67], v[76:79], v[48:51]
  ds_read_b128 v[120:123], v39 offset:1168
  v_mfma_f32_16x16x32_f16 v[52:55], v[64:67], v[80:83], v[52:55]
  ds_read_b64 v[96:97], v38 offset:2560
  ds_read_b64 v[98:99], v38 offset:2568
  v_mfma_f32_16x16x32_f16 v[56:59], v[64:67], v[84:87], v[56:59]
  ds_read_b64 v[100:101], v38 offset:1536
  ds_read_b64 v[102:103], v38 offset:1544
  v_mfma_f32_16x16x32_f16 v[52:55], v[68:71], v[76:79], v[52:55]
  ds_read_b64 v[104:105], v38 offset:512
  ds_read_b64 v[106:107], v38 offset:520
  v_mfma_f32_16x16x32_f16 v[56:59], v[68:71], v[80:83], v[56:59]
  s_waitcnt lgkmcnt(12)
  v_mfma_f32_16x16x32_f16 v[56:59], v[72:75], v[76:79], v[56:59]
  s_waitcnt lgkmcnt(8)
  v_mfma_f32_16x16x32_f16 v[44:47], v[92:95], v[108:111], v[44:47]
  ds_read_b64 v[60:61], v38 offset:3520
  ds_read_b64 v[62:63], v38 offset:3528
  v_mfma_f32_16x16x32_f16 v[48:51], v[92:95], v[112:115], v[48:51]
  ds_read_b128 v[76:79], v39 offset:384
  s_waitcnt lgkmcnt(9)
  v_mfma_f32_16x16x32_f16 v[52:55], v[92:95], v[116:119], v[52:55]
  ds_read_b128 v[80:83], v39 offset:640
  v_mfma_f32_16x16x32_f16 v[56:59], v[92:95], v[120:123], v[56:59]
  ds_read_b128 v[84:87], v39 offset:896
  s_waitcnt lgkmcnt(7)
  v_mfma_f32_16x16x32_f16 v[48:51], v[96:99], v[108:111], v[48:51]
  ds_read_b128 v[88:91], v39 offset:1152
  v_mfma_f32_16x16x32_f16 v[52:55], v[96:99], v[112:115], v[52:55]
  ds_read_b64 v[64:65], v38 offset:2496
  ds_read_b64 v[66:67], v38 offset:2504
  v_mfma_f32_16x16x32_f16 v[56:59], v[96:99], v[116:119], v[56:59]
  ds_read_b64 v[68:69], v38 offset:1472
  ds_read_b64 v[70:71], v38 offset:1480
  v_mfma_f32_16x16x32_f16 v[52:55], v[100:103], v[108:111], v[52:55]
  ds_read_b64 v[72:73], v38 offset:448
  ds_read_b64 v[74:75], v38 offset:456
  v_mfma_f32_16x16x32_f16 v[56:59], v[100:103], v[112:115], v[56:59]
  s_waitcnt lgkmcnt(12)
  v_mfma_f32_16x16x32_f16 v[56:59], v[104:107], v[108:111], v[56:59]
  s_waitcnt lgkmcnt(8)
  v_mfma_f32_16x16x32_f16 v[44:47], v[60:63], v[76:79], v[44:47]
  ds_read_b64 v[92:93], v38 offset:3456
  ds_read_b64 v[94:95], v38 offset:3464
  v_mfma_f32_16x16x32_f16 v[48:51], v[60:63], v[80:83], v[48:51]
  ds_read_b128 v[108:111], v39 offset:368
  s_waitcnt lgkmcnt(9)
  v_mfma_f32_16x16x32_f16 v[52:55], v[60:63], v[84:87], v[52:55]
  ds_read_b128 v[112:115], v39 offset:624
  v_mfma_f32_16x16x32_f16 v[56:59], v[60:63], v[88:91], v[56:59]
  ds_read_b128 v[116:119], v39 offset:880
  s_waitcnt lgkmcnt(7)
  v_mfma_f32_16x16x32_f16 v[48:51], v[64:67], v[76:79], v[48:51]
  ds_read_b128 v[120:123], v39 offset:1136
  v_mfma_f32_16x16x32_f16 v[52:55], v[64:67], v[80:83], v[52:55]
  ds_read_b64 v[96:97], v38 offset:2432
  ds_read_b64 v[98:99], v38 offset:2440
  v_mfma_f32_16x16x32_f16 v[56:59], v[64:67], v[84:87], v[56:59]
  ds_read_b64 v[100:101], v38 offset:1408
  ds_read_b64 v[102:103], v38 offset:1416
  v_mfma_f32_16x16x32_f16 v[52:55], v[68:71], v[76:79], v[52:55]
  ds_read_b64 v[104:105], v38 offset:384
  ds_read_b64 v[106:107], v38 offset:392
  v_mfma_f32_16x16x32_f16 v[56:59], v[68:71], v[80:83], v[56:59]
  s_waitcnt lgkmcnt(12)
  v_mfma_f32_16x16x32_f16 v[56:59], v[72:75], v[76:79], v[56:59]
  s_waitcnt lgkmcnt(8)
  v_mfma_f32_16x16x32_f16 v[44:47], v[92:95], v[108:111], v[44:47]
  ds_read_b64 v[60:61], v38 offset:3392
  ds_read_b64 v[62:63], v38 offset:3400
  v_mfma_f32_16x16x32_f16 v[48:51], v[92:95], v[112:115], v[48:51]
  ds_read_b128 v[76:79], v39 offset:352
  s_waitcnt lgkmcnt(9)
  v_mfma_f32_16x16x32_f16 v[52:55], v[92:95], v[116:119], v[52:55]
  ds_read_b128 v[80:83], v39 offset:608
  v_mfma_f32_16x16x32_f16 v[56:59], v[92:95], v[120:123], v[56:59]
  ds_read_b128 v[84:87], v39 offset:864
  s_waitcnt lgkmcnt(7)
  v_mfma_f32_16x16x32_f16 v[48:51], v[96:99], v[108:111], v[48:51]
  ds_read_b128 v[88:91], v39 offset:1120
  v_mfma_f32_16x16x32_f16 v[52:55], v[96:99], v[112:115], v[52:55]
  ds_read_b64 v[64:65], v38 offset:2368
  ds_read_b64 v[66:67], v38 offset:2376
  v_mfma_f32_16x16x32_f16 v[56:59], v[96:99], v[116:119], v[56:59]
  ds_read_b64 v[68:69], v38 offset:1344
  ds_read_b64 v[70:71], v38 offset:1352
  v_mfma_f32_16x16x32_f16 v[52:55], v[100:103], v[108:111], v[52:55]
  ds_read_b64 v[72:73], v38 offset:320
  ds_read_b64 v[74:75], v38 offset:328
  v_mfma_f32_16x16x32_f16 v[56:59], v[100:103], v[112:115], v[56:59]
  s_waitcnt lgkmcnt(12)
  v_mfma_f32_16x16x32_f16 v[56:59], v[104:107], v[108:111], v[56:59]
  s_waitcnt lgkmcnt(8)
  v_mfma_f32_16x16x32_f16 v[44:47], v[60:63], v[76:79], v[44:47]
  ds_read_b64 v[92:93], v38 offset:3328
  ds_read_b64 v[94:95], v38 offset:3336
  v_mfma_f32_16x16x32_f16 v[48:51], v[60:63], v[80:83], v[48:51]
  ds_read_b128 v[108:111], v39 offset:336
  s_waitcnt lgkmcnt(9)
  v_mfma_f32_16x16x32_f16 v[52:55], v[60:63], v[84:87], v[52:55]
  ds_read_b128 v[112:115], v39 offset:592
  v_mfma_f32_16x16x32_f16 v[56:59], v[60:63], v[88:91], v[56:59]
  ds_read_b128 v[116:119], v39 offset:848
  s_waitcnt lgkmcnt(7)
  v_mfma_f32_16x16x32_f16 v[48:51], v[64:67], v[76:79], v[48:51]
  ds_read_b128 v[120:123], v39 offset:1104
  v_mfma_f32_16x16x32_f16 v[52:55], v[64:67], v[80:83], v[52:55]
  ds_read_b64 v[96:97], v38 offset:2304
  ds_read_b64 v[98:99], v38 offset:2312
  v_mfma_f32_16x16x32_f16 v[56:59], v[64:67], v[84:87], v[56:59]
  ds_read_b64 v[100:101], v38 offset:1280
  ds_read_b64 v[102:103], v38 offset:1288
  v_mfma_f32_16x16x32_f16 v[52:55], v[68:71], v[76:79], v[52:55]
  ds_read_b64 v[104:105], v38 offset:256
  ds_read_b64 v[106:107], v38 offset:264
  v_mfma_f32_16x16x32_f16 v[56:59], v[68:71], v[80:83], v[56:59]
  s_waitcnt lgkmcnt(12)
  v_mfma_f32_16x16x32_f16 v[56:59], v[72:75], v[76:79], v[56:59]
  s_waitcnt lgkmcnt(8)
  v_mfma_f32_16x16x32_f16 v[44:47], v[92:95], v[108:111], v[44:47]
  ds_read_b64 v[60:61], v38 offset:3264
  ds_read_b64 v[62:63], v38 offset:3272
  v_mfma_f32_16x16x32_f16 v[48:51], v[92:95], v[112:115], v[48:51]
  ds_read_b128 v[76:79], v39 offset:320
  s_waitcnt lgkmcnt(9)
  v_mfma_f32_16x16x32_f16 v[52:55], v[92:95], v[116:119], v[52:55]
  ds_read_b128 v[80:83], v39 offset:576
  v_mfma_f32_16x16x32_f16 v[56:59], v[92:95], v[120:123], v[56:59]
  ds_read_b128 v[84:87], v39 offset:832
  s_waitcnt lgkmcnt(7)
  v_mfma_f32_16x16x32_f16 v[48:51], v[96:99], v[108:111], v[48:51]
  ds_read_b128 v[88:91], v39 offset:1088
  v_mfma_f32_16x16x32_f16 v[52:55], v[96:99], v[112:115], v[52:55]
  ds_read_b64 v[64:65], v38 offset:2240
  ds_read_b64 v[66:67], v38 offset:2248
  v_mfma_f32_16x16x32_f16 v[56:59], v[96:99], v[116:119], v[56:59]
  ds_read_b64 v[68:69], v38 offset:1216
  ds_read_b64 v[70:71], v38 offset:1224
  v_mfma_f32_16x16x32_f16 v[52:55], v[100:103], v[108:111], v[52:55]
  ds_read_b64 v[72:73], v38 offset:192
  ds_read_b64 v[74:75], v38 offset:200
  v_mfma_f32_16x16x32_f16 v[56:59], v[100:103], v[112:115], v[56:59]
  s_waitcnt lgkmcnt(12)
  v_mfma_f32_16x16x32_f16 v[56:59], v[104:107], v[108:111], v[56:59]
  s_waitcnt lgkmcnt(8)
  v_mfma_f32_16x16x32_f16 v[44:47], v[60:63], v[76:79], v[44:47]
  ds_read_b64 v[92:93], v38 offset:3200
  ds_read_b64 v[94:95], v38 offset:3208
  v_mfma_f32_16x16x32_f16 v[48:51], v[60:63], v[80:83], v[48:51]
  ds_read_b128 v[108:111], v39 offset:304
  s_waitcnt lgkmcnt(9)
  v_mfma_f32_16x16x32_f16 v[52:55], v[60:63], v[84:87], v[52:55]
  ds_read_b128 v[112:115], v39 offset:560
  v_mfma_f32_16x16x32_f16 v[56:59], v[60:63], v[88:91], v[56:59]
  ds_read_b128 v[116:119], v39 offset:816
  s_waitcnt lgkmcnt(7)
  v_mfma_f32_16x16x32_f16 v[48:51], v[64:67], v[76:79], v[48:51]
  ds_read_b128 v[120:123], v39 offset:1072
  v_mfma_f32_16x16x32_f16 v[52:55], v[64:67], v[80:83], v[52:55]
  ds_read_b64 v[96:97], v38 offset:2176
  ds_read_b64 v[98:99], v38 offset:2184
  v_mfma_f32_16x16x32_f16 v[56:59], v[64:67], v[84:87], v[56:59]
  ds_read_b64 v[100:101], v38 offset:1152
  ds_read_b64 v[102:103], v38 offset:1160
  v_mfma_f32_16x16x32_f16 v[52:55], v[68:71], v[76:79], v[52:55]
  ds_read_b64 v[104:105], v38 offset:128
  ds_read_b64 v[106:107], v38 offset:136
  v_mfma_f32_16x16x32_f16 v[56:59], v[68:71], v[80:83], v[56:59]
  s_waitcnt lgkmcnt(12)
  v_mfma_f32_16x16x32_f16 v[56:59], v[72:75], v[76:79], v[56:59]
  s_waitcnt lgkmcnt(8)
  v_mfma_f32_16x16x32_f16 v[44:47], v[92:95], v[108:111], v[44:47]
  ds_read_b64 v[60:61], v38 offset:3136
  ds_read_b64 v[62:63], v38 offset:3144
  v_mfma_f32_16x16x32_f16 v[48:51], v[92:95], v[112:115], v[48:51]
  ds_read_b128 v[76:79], v39 offset:288
  s_waitcnt lgkmcnt(9)
  v_mfma_f32_16x16x32_f16 v[52:55], v[92:95], v[116:119], v[52:55]
  ds_read_b128 v[80:83], v39 offset:544
  v_mfma_f32_16x16x32_f16 v[56:59], v[92:95], v[120:123], v[56:59]
  ds_read_b128 v[84:87], v39 offset:800
  s_waitcnt lgkmcnt(7)
  v_mfma_f32_16x16x32_f16 v[48:51], v[96:99], v[108:111], v[48:51]
  ds_read_b128 v[88:91], v39 offset:1056
  v_mfma_f32_16x16x32_f16 v[52:55], v[96:99], v[112:115], v[52:55]
  ds_read_b64 v[64:65], v38 offset:2112
  ds_read_b64 v[66:67], v38 offset:2120
  v_mfma_f32_16x16x32_f16 v[56:59], v[96:99], v[116:119], v[56:59]
  ds_read_b64 v[68:69], v38 offset:1088
  ds_read_b64 v[70:71], v38 offset:1096
  v_mfma_f32_16x16x32_f16 v[52:55], v[100:103], v[108:111], v[52:55]
  ds_read_b64 v[72:73], v38 offset:64
  ds_read_b64 v[74:75], v38 offset:72
  v_mfma_f32_16x16x32_f16 v[56:59], v[100:103], v[112:115], v[56:59]
  s_waitcnt lgkmcnt(12)
  v_mfma_f32_16x16x32_f16 v[56:59], v[104:107], v[108:111], v[56:59]
  s_waitcnt lgkmcnt(8)
  v_mfma_f32_16x16x32_f16 v[44:47], v[60:63], v[76:79], v[44:47]
  ds_read_b64 v[92:93], v38 offset:3072
  ds_read_b64 v[94:95], v38 offset:3080
  v_mfma_f32_16x16x32_f16 v[48:51], v[60:63], v[80:83], v[48:51]
  ds_read_b128 v[108:111], v39 offset:272
  s_waitcnt lgkmcnt(9)
  v_mfma_f32_16x16x32_f16 v[52:55], v[60:63], v[84:87], v[52:55]
  ds_read_b128 v[112:115], v39 offset:528
  v_mfma_f32_16x16x32_f16 v[56:59], v[60:63], v[88:91], v[56:59]
  ds_read_b128 v[116:119], v39 offset:784
  s_waitcnt lgkmcnt(7)
  v_mfma_f32_16x16x32_f16 v[48:51], v[64:67], v[76:79], v[48:51]
  ds_read_b128 v[120:123], v39 offset:1040
  v_mfma_f32_16x16x32_f16 v[52:55], v[64:67], v[80:83], v[52:55]
  ds_read_b64 v[96:97], v38 offset:2048
  ds_read_b64 v[98:99], v38 offset:2056
  v_mfma_f32_16x16x32_f16 v[56:59], v[64:67], v[84:87], v[56:59]
  ds_read_b64 v[100:101], v38 offset:1024
  ds_read_b64 v[102:103], v38 offset:1032
  v_mfma_f32_16x16x32_f16 v[52:55], v[68:71], v[76:79], v[52:55]
  ds_read_b64 v[104:105], v38 offset:0
  ds_read_b64 v[106:107], v38 offset:8
  v_mfma_f32_16x16x32_f16 v[56:59], v[68:71], v[80:83], v[56:59]
  s_waitcnt lgkmcnt(12)
  v_mfma_f32_16x16x32_f16 v[56:59], v[72:75], v[76:79], v[56:59]
  s_waitcnt lgkmcnt(8)
  v_mfma_f32_16x16x32_f16 v[44:47], v[92:95], v[108:111], v[44:47]
  v_mfma_f32_16x16x32_f16 v[48:51], v[92:95], v[112:115], v[48:51]
  s_waitcnt lgkmcnt(6)
  v_mfma_f32_16x16x32_f16 v[52:55], v[92:95], v[116:119], v[52:55]
  v_mfma_f32_16x16x32_f16 v[56:59], v[92:95], v[120:123], v[56:59]
  s_waitcnt lgkmcnt(2)
  v_mfma_f32_16x16x32_f16 v[48:51], v[96:99], v[108:111], v[48:51]
  v_mfma_f32_16x16x32_f16 v[52:55], v[96:99], v[112:115], v[52:55]
  v_mfma_f32_16x16x32_f16 v[56:59], v[96:99], v[116:119], v[56:59]
  v_mfma_f32_16x16x32_f16 v[52:55], v[100:103], v[108:111], v[52:55]
  v_mfma_f32_16x16x32_f16 v[56:59], v[100:103], v[112:115], v[56:59]
  s_waitcnt lgkmcnt(0)
  v_mfma_f32_16x16x32_f16 v[56:59], v[104:107], v[108:111], v[56:59]
  s_branch JOIN
HELPER:
  s_cmp_ge_u32 s2, 256
  s_cbranch_scc1 END
  s_mov_b32 s97, 0
  s_load_dwordx16 s[16:31], s[0:1], 0
  s_load_dwordx2 s[46:47], s[0:1], 128
  s_load_dwordx4 s[36:39], s[0:1], 80
  s_load_dwordx4 s[40:43], s[0:1], 96
  s_load_dwordx2 s[32:33], s[0:1], 64
  s_load_dwordx2 s[44:45], s[0:1], 112
  s_getpc_b64 s[50:51]
PCBASE2:
  v_lshlrev_b32 v2, 4, v0
  s_bfe_u32 s57, s2, 0x20003
  s_mulk_i32 s57, 12288
  s_sub_u32 s50, s50, PCBASE2-recurrent_scan__ssm_conv_s4__mixer_s_mlp__prompt_kernel
  s_subb_u32 s51, s51, 0
  s_min_u32 s57, s57, CODE_END-recurrent_scan__ssm_conv_s4__mixer_s_mlp__prompt_kernel-12288
  v_add_u32 v2, s57, v2
  v_add_u32 v3, 4096, v2
  global_load_dwordx4 v[128:131], v2, s[50:51]
  global_load_dwordx4 v[128:131], v3, s[50:51]
  s_cmp_ge_u32 s2, 252
  s_cbranch_scc1 END
  v_lshrrev_b32 v1, 6, v0
  v_and_b32 v0, 63, v0
  s_sub_u32 s53, s2, 224
  v_readfirstlane_b32 s52, v1
  s_lshr_b32 s54, s53, 2
  s_and_b32 s59, s53, 3
  v_lshrrev_b32 v5, 3, v0
  v_lshlrev_b32 v6, 1, v5
  v_and_b32 v6, 4, v6
  v_and_b32 v7, 7, v0
  v_xor_b32 v6, v6, v7
  v_lshlrev_b32 v6, 4, v6
  v_mul_u32_u24 v3, 3584, v5
  v_add_u32 v3, v3, v6
  v_mul_u32_u24 v4, 896, v5
  v_add_u32 v4, v4, v6
  s_mul_i32 s60, s52, 57344
  s_lshl_b32 s55, s53, 7
  s_add_u32 s60, s60, s55
  s_mul_i32 s61, s59, 28
  s_add_u32 s61, s61, s52
  s_lshl_b32 s63, s61, 11
  s_mul_i32 s61, s61, 14336
  s_lshl_b32 s55, s54, 7
  s_add_u32 s61, s61, s55
  s_mul_i32 s62, s53, 29
  s_add_u32 s62, s62, s52
  s_lshl_b32 s62, s62, 11
  s_add_u32 s62, s62, 11534336
  s_mul_i32 s55, s54, 229376
  s_add_u32 s63, s63, s55
  s_add_u32 s63, s63, 13631488
  s_lshl_b32 s64, s52, 13
  s_mov_b32 s10, 1605632
  s_mov_b32 s11, 0x20000
  s_mov_b32 s14, 1605632
  s_mov_b32 s15, 0x20000
  s_waitcnt lgkmcnt(0)
  s_mov_b32 s91, s52
  s_mov_b32 s8, s40
  s_mov_b32 s9, s41
  s_mov_b32 s12, s42
  s_mov_b32 s13, s43
  s_add_u32 m0, s64, 0
  s_nop 0
  buffer_load_dwordx4 v3, s[8:11], s60 offen lds
  s_add_u32 s60, s60, 28672
  s_add_u32 m0, s64, 1024
  s_nop 0
  buffer_load_dwordx4 v3, s[8:11], s60 offen lds
  s_add_u32 s60, s60, 430080
  s_add_u32 m0, s64, 2048
  s_nop 0
  buffer_load_dwordx4 v3, s[8:11], s60 offen lds
  s_add_u32 s60, s60, 28672
  s_add_u32 m0, s64, 3072
  s_nop 0
  buffer_load_dwordx4 v3, s[8:11], s60 offen lds
  s_add_u32 s60, s60, 430080
  s_add_u32 m0, s64, 4096
  s_nop 0
  buffer_load_dwordx4 v3, s[8:11], s60 offen lds
  s_add_u32 s60, s60, 28672
  s_add_u32 m0, s64, 5120
  s_nop 0
  buffer_load_dwordx4 v3, s[8:11], s60 offen lds
  s_add_u32 s60, s60, 430080
  s_add_u32 m0, s64, 6144
  s_nop 0
  buffer_load_dwordx4 v3, s[8:11], s60 offen lds
  s_add_u32 s60, s60, 28672
  s_add_u32 m0, s64, 7168
  s_nop 0
  buffer_load_dwordx4 v3, s[8:11], s60 offen lds
  s_add_u32 s60, s60, 430080
  s_mov_b32 s4, s46
  s_mov_b32 s5, s47
  s_mov_b32 s6, 33554432
  s_mov_b32 s7, 0x20000
  s_load_dwordx2 s[48:49], s[46:47], 0
  v_and_b32 v14, 31, v0
  v_lshrrev_b32 v15, 5, v0
  v_lshlrev_b32 v2, 4, v0
  v_bfe_u32 v5, v0, 2, 2
  v_lshl_add_u32 v12, v15, 3, v5
  v_lshlrev_b32 v12, 7, v12
  v_lshlrev_b32 v5, 1, v5
  v_and_b32 v5, 4, v5
  v_bfe_u32 v6, v0, 4, 1
  v_lshl_or_b32 v5, v6, 1, v5
  v_and_b32 v6, 1, v0
  v_or_b32 v5, v5, v6
  v_bfe_u32 v6, v0, 1, 1
  v_lshl_add_u32 v12, v6, 3, v12
  v_add_u32 v12, s64, v12
  v_lshl_add_u32 v16, v5, 4, v12
  v_xor_b32 v5, 4, v5
  v_lshl_add_u32 v17, v5, 4, v12
  v_add_u32 v18, 0x10000, v16
  v_add_u32 v19, 0x10000, v17
  v_lshlrev_b32 v7, 6, v14
  v_lshl_add_u32 v7, v15, 2, v7
  s_lshl_b32 s55, s52, 3
  s_add_u32 s55, s55, 0x20000
  v_add_u32 v7, s55, v7
  s_mov_b32 s68, 0x3f803f80
  v_mov_b32 v10, 0
  v_mov_b32 v11, 0
  s_mul_i32 s55, s54, 3328
  s_lshl_b32 s56, s59, 3
  s_add_u32 s55, s55, s56
  s_add_u32 s55, s55, 917504
  v_mul_u32_u24 v6, 26624, v0
  v_add_u32 v6, s55, v6
  s_mov_b32 s84, -1
  s_mov_b32 s85, 0
  s_waitcnt lgkmcnt(0)
  s_add_u32 s48, s48, 1
  s_addc_u32 s49, s49, 0
  v_mov_b32 v8, s48
  v_mov_b32 v9, s49
  s_waitcnt vmcnt(6)
  ds_read_b64_tr_b16 v[32:33], v16 offset:0
  ds_read_b64_tr_b16 v[34:35], v16 offset:512
  ds_read_b64_tr_b16 v[36:37], v17 offset:0
  ds_read_b64_tr_b16 v[38:39], v17 offset:512
  s_waitcnt lgkmcnt(0)
  buffer_store_dwordx4 v[32:35], v2, s[4:7], s62 offen sc1
  buffer_store_dwordx4 v[36:39], v2, s[4:7], s62 offen offset:1024 sc1
  s_add_u32 s62, s62, 16384
  v_dot2_f32_bf16 v10, v32, s68, v10
  v_dot2_f32_bf16 v11, v36, s68, v11
  v_dot2_f32_bf16 v10, v33, s68, v10
  v_dot2_f32_bf16 v11, v37, s68, v11
  v_dot2_f32_bf16 v10, v34, s68, v10
  v_dot2_f32_bf16 v11, v38, s68, v11
  v_dot2_f32_bf16 v10, v35, s68, v10
  v_dot2_f32_bf16 v11, v39, s68, v11
  s_waitcnt vmcnt(6)
  ds_read_b64_tr_b16 v[40:41], v16 offset:2048
  ds_read_b64_tr_b16 v[42:43], v16 offset:2560
  ds_read_b64_tr_b16 v[44:45], v17 offset:2048
  ds_read_b64_tr_b16 v[46:47], v17 offset:2560
  s_waitcnt lgkmcnt(0)
  buffer_store_dwordx4 v[40:43], v2, s[4:7], s62 offen sc1
  buffer_store_dwordx4 v[44:47], v2, s[4:7], s62 offen offset:1024 sc1
  s_add_u32 s62, s62, 16384
  v_dot2_f32_bf16 v10, v40, s68, v10
  v_dot2_f32_bf16 v11, v44, s68, v11
  v_dot2_f32_bf16 v10, v41, s68, v10
  v_dot2_f32_bf16 v11, v45, s68, v11
  v_dot2_f32_bf16 v10, v42, s68, v10
  v_dot2_f32_bf16 v11, v46, s68, v11
  v_dot2_f32_bf16 v10, v43, s68, v10
  v_dot2_f32_bf16 v11, v47, s68, v11
  s_waitcnt vmcnt(6)
  ds_read_b64_tr_b16 v[48:49], v16 offset:4096
  ds_read_b64_tr_b16 v[50:51], v16 offset:4608
  ds_read_b64_tr_b16 v[52:53], v17 offset:4096
  ds_read_b64_tr_b16 v[54:55], v17 offset:4608
  s_waitcnt lgkmcnt(0)
  buffer_store_dwordx4 v[48:51], v2, s[4:7], s62 offen sc1
  buffer_store_dwordx4 v[52:55], v2, s[4:7], s62 offen offset:1024 sc1
  s_add_u32 s62, s62, 16384
  v_dot2_f32_bf16 v10, v48, s68, v10
  v_dot2_f32_bf16 v11, v52, s68, v11
  v_dot2_f32_bf16 v10, v49, s68, v10
  v_dot2_f32_bf16 v11, v53, s68, v11
  v_dot2_f32_bf16 v10, v50, s68, v10
  v_dot2_f32_bf16 v11, v54, s68, v11
  v_dot2_f32_bf16 v10, v51, s68, v10
  v_dot2_f32_bf16 v11, v55, s68, v11
  s_waitcnt vmcnt(6)
  ds_read_b64_tr_b16 v[56:57], v16 offset:6144
  ds_read_b64_tr_b16 v[58:59], v16 offset:6656
  ds_read_b64_tr_b16 v[60:61], v17 offset:6144
  ds_read_b64_tr_b16 v[62:63], v17 offset:6656
  s_waitcnt lgkmcnt(0)
  s_cmp_ge_u32 s52, 4
  s_cselect_b32 s62, 0x80000000, s62
  buffer_store_dwordx4 v[56:59], v2, s[4:7], s62 offen sc1
  buffer_store_dwordx4 v[60:63], v2, s[4:7], s62 offen offset:1024 sc1
  v_dot2_f32_bf16 v10, v56, s68, v10
  v_dot2_f32_bf16 v11, v60, s68, v11
  v_dot2_f32_bf16 v10, v57, s68, v10
  v_dot2_f32_bf16 v11, v61, s68, v11
  v_dot2_f32_bf16 v10, v58, s68, v10
  v_dot2_f32_bf16 v11, v62, s68, v11
  v_dot2_f32_bf16 v10, v59, s68, v10
  v_dot2_f32_bf16 v11, v63, s68, v11
  s_nop 1
  ds_write_b32 v7, v10
  ds_write_b32 v7, v11 offset:2048
  s_waitcnt lgkmcnt(0)
  s_barrier
  s_cmp_lg_u32 s52, 7
  s_cbranch_scc1 HELP4
  v_lshlrev_b32 v7, 6, v0
  v_add_u32 v7, 0x20000, v7
  ds_read_b128 v[64:67], v7 offset:0
  ds_read_b128 v[68:71], v7 offset:16
  ds_read_b128 v[72:75], v7 offset:32
  ds_read_b128 v[76:79], v7 offset:48
  s_waitcnt lgkmcnt(0)
  v_add_f32 v64, v64, v72
  v_add_f32 v65, v65, v73
  v_add_f32 v66, v66, v74
  v_add_f32 v67, v67, v75
  v_add_f32 v68, v68, v76
  v_add_f32 v69, v69, v77
  v_add_f32 v70, v70, v78
  v_add_f32 v71, v71, v79
  v_add_f32 v64, v64, v68
  v_add_f32 v65, v65, v69
  v_add_f32 v66, v66, v70
  v_add_f32 v67, v67, v71
  v_add_f32 v64, v64, v66
  v_add_f32 v65, v65, v67
  v_add_f32 v64, v64, v65
  v_cvt_pk_bf16_f32 v65, v64, v64
  v_and_b32 v65, 0xffff0000, v65
  v_sub_f32 v64, v64, v65
  v_cvt_pk_bf16_f32 v66, v64, v64
  v_and_b32 v66, 0xffff0000, v66
  v_sub_f32 v64, v64, v66
  v_cvt_pk_bf16_f32 v20, v65, v66
  v_cvt_pk_bf16_f32 v21, v64, 0
  v_mov_b32 v22, 0
  v_mov_b32 v23, 0
  v_mov_b32 v24, 0
  v_mov_b32 v25, 0
  v_mov_b32 v26, 0
  v_mov_b32 v27, 0
  v_lshlrev_b32 v7, 4, v14
  v_lshl_add_u32 v7, v15, 10, v7
  s_mul_i32 s55, s53, 59392
  s_add_u32 s55, s55, 11591680
  buffer_store_dwordx4 v[20:23], v7, s[4:7], s55 offen sc1
  buffer_store_dwordx4 v[24:27], v7, s[4:7], s55 offen offset:512 sc1
HELP4:
  s_waitcnt vmcnt(0)
  s_barrier
  s_cmp_eq_u32 s52, 0
  s_cselect_b64 exec, s[84:85], 0
  buffer_store_dwordx2 v[8:9], v6, s[4:7], 0 offen offset:0 sc1
  s_mov_b64 exec, -1
  s_add_u32 m0, s64, 65536
  s_nop 0
  buffer_load_dwordx4 v4, s[12:15], s61 offen lds
  s_add_u32 s61, s61, 7168
  s_add_u32 m0, s64, 66560
  s_nop 0
  buffer_load_dwordx4 v4, s[12:15], s61 offen lds
  s_add_u32 s61, s61, 107520
  s_add_u32 m0, s64, 67584
  s_nop 0
  buffer_load_dwordx4 v4, s[12:15], s61 offen lds
  s_add_u32 s61, s61, 7168
  s_add_u32 m0, s64, 68608
  s_nop 0
  buffer_load_dwordx4 v4, s[12:15], s61 offen lds
  s_add_u32 s61, s61, 107520
  s_add_u32 m0, s64, 69632
  s_nop 0
  buffer_load_dwordx4 v4, s[12:15], s61 offen lds
  s_add_u32 s61, s61, 7168
  s_add_u32 m0, s64, 70656
  s_nop 0
  buffer_load_dwordx4 v4, s[12:15], s61 offen lds
  s_add_u32 s61, s61, 107520
  s_add_u32 m0, s64, 71680
  s_nop 0
  buffer_load_dwordx4 v4, s[12:15], s61 offen lds
  s_add_u32 s61, s61, 7168
  s_add_u32 m0, s64, 72704
  s_nop 0
  buffer_load_dwordx4 v4, s[12:15], s61 offen lds
  s_add_u32 s61, s61, 107520
  s_and_b32 s55, s2, 7
  s_lshl_b32 s55, s55, 2
  s_lshr_b32 s56, s2, 3
  s_and_b32 s56, s56, 3
  s_add_u32 s55, s55, s56
  s_mul_i32 s92, s55, 26624
  s_add_u32 s92, s92, 917504
  s_add_u32 s95, s92, 1376
  s_load_dwordx16 s[16:31], s[46:47], s95 glc
  s_waitcnt lgkmcnt(0)
  s_cmp_lg_u64 s[16:17], s[48:49]
  s_cselect_b32 s95, 1, 0
  s_cmp_lg_u64 s[18:19], s[48:49]
  s_addc_u32 s95, s95, 0
  s_cmp_lg_u64 s[20:21], s[48:49]
  s_addc_u32 s95, s95, 0
  s_cmp_lg_u64 s[22:23], s[48:49]
  s_addc_u32 s95, s95, 0
  s_cmp_lg_u64 s[24:25], s[48:49]
  s_addc_u32 s95, s95, 0
  s_cmp_lg_u64 s[26:27], s[48:49]
  s_addc_u32 s95, s95, 0
  s_cmp_lg_u64 s[28:29], s[48:49]
  s_addc_u32 s95, s95, 0
  s_cmp_lg_u64 s[30:31], s[48:49]
  s_addc_u32 s95, s95, 0
  s_cmp_eq_u32 s95, 0
  s_cbranch_scc0 SSLOW_54
SBACK_55:
  s_waitcnt vmcnt(6)
  ds_read_b64_tr_b16 v[32:33], v18 offset:0
  ds_read_b64_tr_b16 v[34:35], v18 offset:512
  ds_read_b64_tr_b16 v[36:37], v19 offset:0
  ds_read_b64_tr_b16 v[38:39], v19 offset:512
  s_waitcnt lgkmcnt(0)
  buffer_store_dwordx4 v[32:35], v2, s[4:7], s63 offen sc1
  buffer_store_dwordx4 v[36:39], v2, s[4:7], s63 offen offset:1024 sc1
  s_add_u32 s63, s63, 16384
  s_waitcnt vmcnt(6)
  ds_read_b64_tr_b16 v[40:41], v18 offset:2048
  ds_read_b64_tr_b16 v[42:43], v18 offset:2560
  ds_read_b64_tr_b16 v[44:45], v19 offset:2048
  ds_read_b64_tr_b16 v[46:47], v19 offset:2560
  s_waitcnt lgkmcnt(0)
  buffer_store_dwordx4 v[40:43], v2, s[4:7], s63 offen sc1
  buffer_store_dwordx4 v[44:47], v2, s[4:7], s63 offen offset:1024 sc1
  s_add_u32 s63, s63, 16384
  s_waitcnt vmcnt(6)
  ds_read_b64_tr_b16 v[48:49], v18 offset:4096
  ds_read_b64_tr_b16 v[50:51], v18 offset:4608
  ds_read_b64_tr_b16 v[52:53], v19 offset:4096
  ds_read_b64_tr_b16 v[54:55], v19 offset:4608
  s_waitcnt lgkmcnt(0)
  buffer_store_dwordx4 v[48:51], v2, s[4:7], s63 offen sc1
  buffer_store_dwordx4 v[52:55], v2, s[4:7], s63 offen offset:1024 sc1
  s_add_u32 s63, s63, 16384
  s_waitcnt vmcnt(6)
  ds_read_b64_tr_b16 v[56:57], v18 offset:6144
  ds_read_b64_tr_b16 v[58:59], v18 offset:6656
  ds_read_b64_tr_b16 v[60:61], v19 offset:6144
  ds_read_b64_tr_b16 v[62:63], v19 offset:6656
  s_waitcnt lgkmcnt(0)
  s_cmp_ge_u32 s52, 4
  s_cselect_b32 s63, 0x80000000, s63
  buffer_store_dwordx4 v[56:59], v2, s[4:7], s63 offen sc1
  buffer_store_dwordx4 v[60:63], v2, s[4:7], s63 offen offset:1024 sc1
  s_waitcnt vmcnt(0)
  s_barrier
  s_cmp_eq_u32 s52, 0
  s_cselect_b64 exec, s[84:85], 0
  buffer_store_dwordx2 v[8:9], v6, s[4:7], 0 offen offset:32 sc1
  s_mov_b64 exec, -1
  s_branch END
SSLOW_1:
  s_mov_b32 s96, 40000
SSLOW_1_l:
  s_load_dwordx8 s[16:23], s[46:47], s92 glc
  s_waitcnt lgkmcnt(0)
  s_cmp_lg_u64 s[16:17], s[48:49]
  s_cselect_b32 s95, 1, 0
  s_cmp_lg_u64 s[18:19], s[48:49]
  s_addc_u32 s95, s95, 0
  s_cmp_lg_u64 s[20:21], s[48:49]
  s_addc_u32 s95, s95, 0
  s_cmp_lg_u64 s[22:23], s[48:49]
  s_addc_u32 s95, s95, 0
  s_cmp_eq_u32 s95, 0
  s_cbranch_scc1 SBACK_2
  s_sub_u32 s96, s96, 1
  s_cmp_lg_u32 s96, 0
  s_cbranch_scc1 SSLOW_1_l
  s_or_b32 s97, s97, 1
  s_branch SBACK_2
SSLOW_21:
  s_mov_b32 s96, 40000
SSLOW_21_l:
  s_load_dwordx8 s[16:23], s[46:47], s74 glc
  s_add_u32 s95, s74, 112
  s_load_dwordx8 s[24:31], s[46:47], s95 glc
  s_load_dwordx8 s[36:43], s[46:47], s75 glc
  s_waitcnt lgkmcnt(0)
  s_cmp_lg_u64 s[16:17], s[48:49]
  s_cselect_b32 s95, 1, 0
  s_cmp_lg_u64 s[18:19], s[48:49]
  s_addc_u32 s95, s95, 0
  s_cmp_lg_u64 s[20:21], s[48:49]
  s_addc_u32 s95, s95, 0
  s_cmp_lg_u64 s[22:23], s[48:49]
  s_addc_u32 s95, s95, 0
  s_cmp_lg_u64 s[24:25], s[48:49]
  s_addc_u32 s95, s95, 0
  s_cmp_lg_u64 s[26:27], s[48:49]
  s_addc_u32 s95, s95, 0
  s_cmp_lg_u64 s[28:29], s[48:49]
  s_addc_u32 s95, s95, 0
  s_cmp_lg_u64 s[30:31], s[48:49]
  s_addc_u32 s95, s95, 0
  s_cmp_lg_u64 s[36:37], s[48:49]
  s_addc_u32 s95, s95, 0
  s_cmp_lg_u64 s[38:39], s[48:49]
  s_addc_u32 s95, s95, 0
  s_cmp_lg_u64 s[40:41], s[48:49]
  s_addc_u32 s95, s95, 0
  s_cmp_lg_u64 s[42:43], s[48:49]
  s_addc_u32 s95, s95, 0
  s_cmp_eq_u32 s95, 0
  s_cbranch_scc1 SBACK_22
  s_sub_u32 s96, s96, 1
  s_cmp_lg_u32 s96, 0
  s_cbranch_scc1 SSLOW_21_l
  s_or_b32 s97, s97, 4
  s_branch SBACK_22
SSLOW_23:
  s_mov_b32 s96, 40000
SSLOW_23_l:
  s_load_dwordx8 s[16:23], s[46:47], s92 glc
  s_waitcnt lgkmcnt(0)
  s_cmp_lg_u64 s[16:17], s[48:49]
  s_cselect_b32 s95, 1, 0
  s_cmp_lg_u64 s[18:19], s[48:49]
  s_addc_u32 s95, s95, 0
  s_cmp_lg_u64 s[20:21], s[48:49]
  s_addc_u32 s95, s95, 0
  s_cmp_lg_u64 s[22:23], s[48:49]
  s_addc_u32 s95, s95, 0
  s_cmp_eq_u32 s95, 0
  s_cbranch_scc1 SBACK_24
  s_sub_u32 s96, s96, 1
  s_cmp_lg_u32 s96, 0
  s_cbranch_scc1 SSLOW_23_l
  s_or_b32 s97, s97, 1
  s_branch SBACK_24
SSLOW_29:
  s_mov_b32 s96, 40000
SSLOW_29_l:
  s_load_dwordx16 s[16:31], s[46:47], s74 glc
  s_waitcnt lgkmcnt(0)
  s_cmp_lg_u64 s[16:17], s[48:49]
  s_cselect_b32 s95, 1, 0
  s_cmp_lg_u64 s[18:19], s[48:49]
  s_addc_u32 s95, s95, 0
  s_cmp_lg_u64 s[20:21], s[48:49]
  s_addc_u32 s95, s95, 0
  s_cmp_lg_u64 s[22:23], s[48:49]
  s_addc_u32 s95, s95, 0
  s_cmp_lg_u64 s[24:25], s[48:49]
  s_addc_u32 s95, s95, 0
  s_cmp_lg_u64 s[26:27], s[48:49]
  s_addc_u32 s95, s95, 0
  s_cmp_lg_u64 s[28:29], s[48:49]
  s_addc_u32 s95, s95, 0
  s_cmp_eq_u32 s95, 0
  s_cbranch_scc1 SBACK_30
  s_sub_u32 s96, s96, 1
  s_cmp_lg_u32 s96, 0
  s_cbranch_scc1 SSLOW_29_l
  s_or_b32 s97, s97, 8
  s_branch SBACK_30
SSLOW_31:
  s_mov_b32 s96, 40000
SSLOW_31_l:
  s_add_u32 s95, s92, 32
  s_load_dwordx8 s[16:23], s[46:47], s95 glc
  s_waitcnt lgkmcnt(0)
  s_cmp_lg_u64 s[16:17], s[48:49]
  s_cselect_b32 s95, 1, 0
  s_cmp_lg_u64 s[18:19], s[48:49]
  s_addc_u32 s95, s95, 0
  s_cmp_lg_u64 s[20:21], s[48:49]
  s_addc_u32 s95, s95, 0
  s_cmp_lg_u64 s[22:23], s[48:49]
  s_addc_u32 s95, s95, 0
  s_cmp_eq_u32 s95, 0
  s_cbranch_scc1 SBACK_32
  s_sub_u32 s96, s96, 1
  s_cmp_lg_u32 s96, 0
  s_cbranch_scc1 SSLOW_31_l
  s_or_b32 s97, s97, 64
  s_branch SBACK_32
SSLOW_34:
  s_waitcnt vmcnt(0)
  s_mov_b64 exec, 0x7f
  buffer_store_dwordx2 v[8:9], v5, s[4:7], 0 offen offset:2560 sc1
  s_mov_b64 exec, -1
  s_mov_b32 s61, 1
  s_mov_b32 s96, 40000
SSLOW_34_l:
  s_load_dwordx16 s[16:31], s[46:47], s62 glc
  s_waitcnt lgkmcnt(0)
  s_cmp_lg_u64 s[16:17], s[48:49]
  s_cselect_b32 s95, 1, 0
  s_cmp_lg_u64 s[18:19], s[48:49]
  s_addc_u32 s95, s95, 0
  s_cmp_lg_u64 s[20:21], s[48:49]
  s_addc_u32 s95, s95, 0
  s_cmp_lg_u64 s[22:23], s[48:49]
  s_addc_u32 s95, s95, 0
  s_cmp_lg_u64 s[24:25], s[48:49]
  s_addc_u32 s95, s95, 0
  s_cmp_lg_u64 s[26:27], s[48:49]
  s_addc_u32 s95, s95, 0
  s_cmp_lg_u64 s[28:29], s[48:49]
  s_addc_u32 s95, s95, 0
  s_cmp_eq_u32 s95, 0
  s_cbranch_scc1 SBACK_35
  s_sub_u32 s96, s96, 1
  s_cmp_lg_u32 s96, 0
  s_cbranch_scc1 SSLOW_34_l
  s_or_b32 s97, s97, 16
  s_branch SBACK_35
SSLOW_37:
  s_mov_b32 s96, 40000
SSLOW_37_l:
  s_add_u32 s95, s62, 512
  s_load_dwordx16 s[16:31], s[46:47], s95 glc
  s_waitcnt lgkmcnt(0)
  s_cmp_lg_u64 s[16:17], s[48:49]
  s_cselect_b32 s95, 1, 0
  s_cmp_lg_u64 s[18:19], s[48:49]
  s_addc_u32 s95, s95, 0
  s_cmp_lg_u64 s[20:21], s[48:49]
  s_addc_u32 s95, s95, 0
  s_cmp_lg_u64 s[22:23], s[48:49]
  s_addc_u32 s95, s95, 0
  s_cmp_lg_u64 s[24:25], s[48:49]
  s_addc_u32 s95, s95, 0
  s_cmp_lg_u64 s[26:27], s[48:49]
  s_addc_u32 s95, s95, 0
  s_cmp_lg_u64 s[28:29], s[48:49]
  s_addc_u32 s95, s95, 0
  s_cmp_eq_u32 s95, 0
  s_cbranch_scc1 SBACK_38
  s_sub_u32 s96, s96, 1
  s_cmp_lg_u32 s96, 0
  s_cbranch_scc1 SSLOW_37_l
  s_or_b32 s97, s97, 32
  s_branch SBACK_38
SSLOW_45:
  s_waitcnt vmcnt(0)
  s_mov_b64 exec, 0x7f
  buffer_store_dwordx2 v[8:9], v5, s[4:7], 0 offen offset:2560 sc1
  s_mov_b64 exec, -1
  s_mov_b32 s61, 1
  s_mov_b32 s96, 40000
SSLOW_45_l:
  s_load_dwordx16 s[16:31], s[46:47], s62 glc
  s_waitcnt lgkmcnt(0)
  s_cmp_lg_u64 s[16:17], s[48:49]
  s_cselect_b32 s95, 1, 0
  s_cmp_lg_u64 s[18:19], s[48:49]
  s_addc_u32 s95, s95, 0
  s_cmp_lg_u64 s[20:21], s[48:49]
  s_addc_u32 s95, s95, 0
  s_cmp_lg_u64 s[22:23], s[48:49]
  s_addc_u32 s95, s95, 0
  s_cmp_lg_u64 s[24:25], s[48:49]
  s_addc_u32 s95, s95, 0
  s_cmp_lg_u64 s[26:27], s[48:49]
  s_addc_u32 s95, s95, 0
  s_cmp_lg_u64 s[28:29], s[48:49]
  s_addc_u32 s95, s95, 0
  s_cmp_eq_u32 s95, 0
  s_cbranch_scc1 SBACK_46
  s_sub_u32 s96, s96, 1
  s_cmp_lg_u32 s96, 0
  s_cbranch_scc1 SSLOW_45_l
  s_or_b32 s97, s97, 16
  s_branch SBACK_46
SSLOW_48:
  s_mov_b32 s96, 40000
SSLOW_48_l:
  s_add_u32 s95, s62, 512
  s_load_dwordx16 s[16:31], s[46:47], s95 glc
  s_waitcnt lgkmcnt(0)
  s_cmp_lg_u64 s[16:17], s[48:49]
  s_cselect_b32 s95, 1, 0
  s_cmp_lg_u64 s[18:19], s[48:49]
  s_addc_u32 s95, s95, 0
  s_cmp_lg_u64 s[20:21], s[48:49]
  s_addc_u32 s95, s95, 0
  s_cmp_lg_u64 s[22:23], s[48:49]
  s_addc_u32 s95, s95, 0
  s_cmp_lg_u64 s[24:25], s[48:49]
  s_addc_u32 s95, s95, 0
  s_cmp_lg_u64 s[26:27], s[48:49]
  s_addc_u32 s95, s95, 0
  s_cmp_lg_u64 s[28:29], s[48:49]
  s_addc_u32 s95, s95, 0
  s_cmp_eq_u32 s95, 0
  s_cbranch_scc1 SBACK_49
  s_sub_u32 s96, s96, 1
  s_cmp_lg_u32 s96, 0
  s_cbranch_scc1 SSLOW_48_l
  s_or_b32 s97, s97, 32
  s_branch SBACK_49
SSLOW_54:
  s_mov_b32 s96, 40000
SSLOW_54_l:
  s_add_u32 s95, s92, 1376
  s_load_dwordx16 s[16:31], s[46:47], s95 glc
  s_waitcnt lgkmcnt(0)
  s_cmp_lg_u64 s[16:17], s[48:49]
  s_cselect_b32 s95, 1, 0
  s_cmp_lg_u64 s[18:19], s[48:49]
  s_addc_u32 s95, s95, 0
  s_cmp_lg_u64 s[20:21], s[48:49]
  s_addc_u32 s95, s95, 0
  s_cmp_lg_u64 s[22:23], s[48:49]
  s_addc_u32 s95, s95, 0
  s_cmp_lg_u64 s[24:25], s[48:49]
  s_addc_u32 s95, s95, 0
  s_cmp_lg_u64 s[26:27], s[48:49]
  s_addc_u32 s95, s95, 0
  s_cmp_lg_u64 s[28:29], s[48:49]
  s_addc_u32 s95, s95, 0
  s_cmp_lg_u64 s[30:31], s[48:49]
  s_addc_u32 s95, s95, 0
  s_cmp_eq_u32 s95, 0
  s_cbranch_scc1 SBACK_55
  s_sub_u32 s96, s96, 1
  s_cmp_lg_u32 s96, 0
  s_cbranch_scc1 SSLOW_54_l
  s_or_b32 s97, s97, 64
  s_branch SBACK_55
PSLOW_7:
  s_mov_b32 s96, 40000
PSLOW_7_l:
  buffer_load_dwordx2 v[124:125], v6, s[4:7], 0 offen offset:384 sc1
  s_waitcnt vmcnt(0)
  v_cmp_ne_u64 vcc, v[124:125], v[8:9]
  s_cbranch_vccz PBACK_8
  s_sleep 1
  s_sub_u32 s96, s96, 1
  s_cmp_lg_u32 s96, 0
  s_cbranch_scc1 PSLOW_7_l
  s_or_b32 s97, s97, 2
  s_branch PBACK_8
PSLOW_39:
  s_mov_b32 s96, 40000
PSLOW_39_l:
  buffer_load_dwordx2 v[10:11], v6, s[4:7], 0 offen offset:640 sc1
  s_waitcnt vmcnt(0)
  v_cmp_ne_u64 vcc, v[10:11], v[8:9]
  s_cbranch_vccz PBACK_40
  s_sleep 1
  s_sub_u32 s96, s96, 1
  s_cmp_lg_u32 s96, 0
  s_cbranch_scc1 PSLOW_39_l
  s_or_b32 s97, s97, 256
  s_branch PBACK_40
PSLOW_50:
  s_mov_b32 s96, 40000
PSLOW_50_l:
  buffer_load_dwordx2 v[10:11], v6, s[4:7], 0 offen offset:640 sc1
  s_waitcnt vmcnt(0)
  v_cmp_ne_u64 vcc, v[10:11], v[8:9]
  s_cbranch_vccz PBACK_51
  s_sleep 1
  s_sub_u32 s96, s96, 1
  s_cmp_lg_u32 s96, 0
  s_cbranch_scc1 PSLOW_50_l
  s_or_b32 s97, s97, 256
  s_branch PBACK_51
CODE_END:
.section .rodata,"a"
.p2align 6
.amdhsa_kernel recurrent_scan__ssm_conv_s4__mixer_s_mlp__prompt_kernel
  .amdhsa_next_free_vgpr 256
  .amdhsa_next_free_sgpr 102
  .amdhsa_accum_offset 136
  .amdhsa_group_segment_fixed_size 0
  .amdhsa_kernarg_size 136
  .amdhsa_user_sgpr_count 2
  .amdhsa_user_sgpr_kernarg_segment_ptr 1
  .amdhsa_system_sgpr_workgroup_id_x 1
.end_amdhsa_kernel
```
